```python
import torch

def _softmax(x, axis=-1):
    return torch.softmax(x, dim=axis)
def _gelu(x):
    return torch.nn.functional.gelu(x, approximate="tanh")
def _silu(x):
    return torch.nn.functional.silu(x)
def _sigmoid(x):
    return torch.sigmoid(x)
def _layernorm(x, axis=-1, eps=1e-5):
    m = x.mean(dim=axis, keepdim=True)
    v = x.var(dim=axis, keepdim=True, unbiased=False)
    return (x - m) / torch.sqrt(v + eps)
def _scatter_add(tgt, idx, src, axis=0):
    return tgt.clone().index_add_(axis, idx, src)
def _segment_sum(src, seg, n):
    out = torch.zeros((n,) + src.shape[1:], dtype=src.dtype)
    return out.index_add_(0, seg, src)
def _pad(x, pw):
    flat = tuple(v for pair in reversed(pw) for v in pair)
    return torch.nn.functional.pad(x, flat)

kernel_name = 'standalone__gqa_block_cached__near_ridge'

def setup_inputs():

    _w = (lambda a: (lambda t: t.to(torch.bfloat16) if t.is_floating_point() else t)(torch.as_tensor(a)))
    B, Sq, D = 8, 48, 512
    Hq, Hkv, Sk, Dh = 32, 8, 2048, 128
    assert Hq % Hkv == 0, (Hq, Hkv)
    return {
        "x": _w((lambda *s: torch.randn(*s, dtype=torch.bfloat16) * 0.8)(B, Sq, D)),
        "k_cache": _w((lambda *s: torch.randn(*s, dtype=torch.bfloat16) * 0.8)(B, Hkv, Sk, Dh)),
        "v_cache": _w((lambda *s: torch.randn(*s, dtype=torch.bfloat16) * 0.05)(B, Hkv, Sk, Dh)),
        "wq": _w((lambda *s: torch.randn(*s, dtype=torch.bfloat16) * 0.8)(D, Hq * Dh) * (D ** -0.5)),
        "wo": _w((lambda *s: torch.randn(*s, dtype=torch.bfloat16) * 0.05)(Hq * Dh, D) * ((Hq * Dh) ** -0.5)),
    }

def reference(x, k_cache, v_cache, wq, wo):
    B, Sq, D = x.shape
    Hq, Dh = 32, 128
    Hkv = k_cache.shape[1]
    rep = Hq // Hkv
    q = (lambda x, *d: x.permute(*d))((x @ wq).reshape(B, Sq, Hq, Dh), 0, 2, 1, 3)
    k = (lambda x, n, axis: torch.repeat_interleave(x, n, dim=axis))(k_cache, rep, axis=1)
    v = (lambda x, n, axis: torch.repeat_interleave(x, n, dim=axis))(v_cache, rep, axis=1)
    scores = torch.einsum("bhqd,bhkd->bhqk", q, k) * (Dh ** -0.5)
    p = _softmax(scores, axis=-1)
    o = torch.einsum("bhqk,bhkd->bhqd", p, v)
    return (lambda x, *d: x.permute(*d))(o, 0, 2, 1, 3).reshape(B, Sq, Hq * Dh) @ wo
```

```asm
; @launch grid=(256,1,1) block=(512,1,1) lds=163840
.amdgcn_target "amdgcn-amd-amdhsa--gfx950"
.text
.globl standalone__gqa_block_cached__near_ridge_kernel
.p2align 8
.type standalone__gqa_block_cached__near_ridge_kernel,@function
standalone__gqa_block_cached__near_ridge_kernel:
  s_cmp_ge_u32 s2, 256
  s_cbranch_scc1 L_END
  s_load_dwordx16 s[4:19], s[0:1], 0
  s_getpc_b64 s[78:79]
  v_lshlrev_b32 v5, 6, v0
  v_min_u32 v5, 0x42f0, v5
  global_load_dword v255, v5, s[78:79]
  s_memrealtime s[80:81]
  v_lshrrev_b32 v4, 6, v0
  v_and_b32 v1, 63, v0
  v_lshrrev_b32 v2, 4, v1
  v_readfirstlane_b32 s3, v4
  v_and_b32 v3, 15, v1
  v_mov_b32 v4, 0x27800
  v_mov_b32 v8, 0
  v_mov_b32 v9, 0
  v_mov_b32 v10, 0
  v_mov_b32 v11, 0
  s_cmp_lg_u32 s3, 4
  s_cbranch_scc1 L_NOZ
  ds_write_b128 v4, v[8:11]
  ds_write_b128 v4, v[8:11] offset:16
L_NOZ:
  s_and_b32 s49, s2, 7
  s_lshr_b32 s48, s2, 5
  s_lshr_b32 s50, s2, 3
  s_and_b32 s50, s50, 3
  s_lshl_b32 s51, s48, 3
  s_add_u32 s51, s51, s49
  s_lshl_b32 s52, s49, 2
  s_add_u32 s52, s52, s50
  s_and_b32 s53, s3, 3
  s_lshl_b32 s77, s48, 5
  s_add_u32 s77, s77, s52
  s_mov_b32 s70, 0x05040100
  s_mov_b32 s71, 0x07060302
  s_mov_b32 s73, 0
  s_waitcnt lgkmcnt(0)
  s_mov_b32 s20, s6
  s_and_b32 s21, s7, 0xffff
  s_mov_b32 s22, 0x2000000
  s_mov_b32 s23, 0x20000
  s_mov_b32 s24, s8
  s_and_b32 s25, s9, 0xffff
  s_mov_b32 s26, 0x2000000
  s_mov_b32 s27, 0x20000
  s_mov_b32 s28, s4
  s_and_b32 s29, s5, 0xffff
  s_mov_b32 s30, 0x60000
  s_mov_b32 s31, 0x20000
  s_mov_b32 s32, s10
  s_and_b32 s33, s11, 0xffff
  s_mov_b32 s34, 0x400000
  s_mov_b32 s35, 0x20000
  s_mov_b32 s36, s14
  s_and_b32 s37, s15, 0xffff
  s_mov_b32 s38, 0x60000
  s_mov_b32 s39, 0x20000
  s_mov_b32 s40, s16
  s_and_b32 s41, s17, 0xffff
  s_mov_b32 s42, 0x100
  s_mov_b32 s43, 0x20000
  s_mov_b32 s44, s18
  s_and_b32 s45, s19, 0xffff
  s_mov_b32 s46, 0x10000000
  s_mov_b32 s47, 0x20000
  s_xor_b32 s55, s3, 4
  s_or_b32 s55, s55, s52
  s_cmp_lg_u32 s55, 0
  s_cbranch_scc1 L_NOLEAD
  s_and_b32 s54, s80, 0xfffffff0
  s_or_b32 s54, s54, 1
  v_mov_b32 v10, s54
  v_mov_b32 v11, s81
  s_lshl_b32 s58, s48, 5
  s_mov_b64 exec, 1
  buffer_store_dwordx2 v[10:11], v8, s[40:43], s58 offen sc1
  s_mov_b64 exec, -1
L_NOLEAD:
  s_barrier
  s_cmp_ge_u32 s3, 4
  s_cbranch_scc1 L_B_START
  v_lshlrev_b32 v6, 4, v3
  v_lshl_add_u32 v4, v2, 16, v6
  v_lshrrev_b32 v8, 2, v1
  v_and_b32 v8, 7, v8
  v_lshrrev_b32 v9, 5, v1
  v_and_b32 v10, 3, v1
  v_lshl_add_u32 v10, v9, 2, v10
  v_lshlrev_b32 v10, 4, v10
  v_lshl_add_u32 v5, v8, 10, v10
  v_xor_b32 v6, 32, v5
  v_add_u32 v6, 0x2000, v6
  s_lshl_b32 s54, s53, 20
  s_lshl_b32 s55, s52, 8
  s_add_u32 s54, s54, s55
  s_mul_i32 s55, s48, 49152
  s_lshl_b32 s56, s53, 8
  s_add_u32 s55, s55, s56
  s_cmp_eq_u32 s53, 3
  s_cselect_b32 s57, 0, s53
  s_add_u32 s58, s57, 0
  s_cmp_ge_u32 s58, 3
  s_cselect_b32 s59, 3, 0
  s_sub_u32 s58, s58, s59
  s_lshl_b32 s59, s58, 14
  s_add_u32 s74, s55, s59
  s_add_u32 s58, s57, 1
  s_cmp_ge_u32 s58, 3
  s_cselect_b32 s59, 3, 0
  s_sub_u32 s58, s58, s59
  s_lshl_b32 s59, s58, 14
  s_add_u32 s75, s55, s59
  s_mov_b32 s100, 0xA000
  s_cmp_eq_u32 s58, 1
  s_cselect_b32 s100, 0x1A000, s100
  s_cmp_eq_u32 s58, 2
  s_cselect_b32 s100, 0x20000, s100
  s_cmp_eq_u32 s53, 3
  s_cselect_b32 s59, 2, 0
  s_lshl_b32 s59, s59, 13
  s_add_u32 s100, s100, s59
  s_add_u32 s58, s57, 2
  s_cmp_ge_u32 s58, 3
  s_cselect_b32 s59, 3, 0
  s_sub_u32 s58, s58, s59
  s_lshl_b32 s59, s58, 14
  s_add_u32 s76, s55, s59
  s_mov_b32 s101, 0xA000
  s_cmp_eq_u32 s58, 1
  s_cselect_b32 s101, 0x1A000, s101
  s_cmp_eq_u32 s58, 2
  s_cselect_b32 s101, 0x20000, s101
  s_cmp_eq_u32 s53, 3
  s_cselect_b32 s59, 2, 1
  s_lshl_b32 s59, s59, 13
  s_add_u32 s101, s101, s59
  s_and_b32 s62, s48, 3
  s_lshl_b32 s56, s62, 18
  s_add_u32 s56, s56, s54
  buffer_load_dwordx4 v[104:107], v4, s[32:35], s56 offen
  s_add_u32 s56, s56, 8192
  buffer_load_dwordx4 v[108:111], v4, s[32:35], s56 offen
  s_add_u32 s56, s56, 8192
  buffer_load_dwordx4 v[112:115], v4, s[32:35], s56 offen
  s_add_u32 s56, s56, 8192
  buffer_load_dwordx4 v[116:119], v4, s[32:35], s56 offen
  s_add_u32 s56, s56, 8192
  buffer_load_dwordx4 v[120:123], v4, s[32:35], s56 offen
  s_add_u32 s56, s56, 8192
  buffer_load_dwordx4 v[124:127], v4, s[32:35], s56 offen
  s_add_u32 s56, s56, 8192
  buffer_load_dwordx4 v[128:131], v4, s[32:35], s56 offen
  s_add_u32 s56, s56, 8192
  buffer_load_dwordx4 v[132:135], v4, s[32:35], s56 offen
  s_add_u32 m0, s100, 0
  s_nop 0
  buffer_load_dwordx4 v5, s[28:31], s74 offen offset:0 lds
  s_add_u32 m0, s100, 2048
  s_nop 0
  buffer_load_dwordx4 v6, s[28:31], s74 offen offset:0 lds
  s_add_u32 m0, s100, 4096
  s_nop 0
  buffer_load_dwordx4 v5, s[28:31], s75 offen offset:0 lds
  s_add_u32 m0, s100, 6144
  s_nop 0
  buffer_load_dwordx4 v6, s[28:31], s75 offen offset:0 lds
  s_add_u32 m0, s101, 0
  s_nop 0
  buffer_load_dwordx4 v5, s[28:31], s76 offen offset:0 lds
  s_add_u32 m0, s101, 2048
  s_nop 0
  buffer_load_dwordx4 v6, s[28:31], s76 offen offset:0 lds
  s_add_u32 m0, s100, 896
  s_nop 0
  buffer_load_dwordx4 v5, s[28:31], s74 offen offset:128 lds
  s_add_u32 m0, s100, 2944
  s_nop 0
  buffer_load_dwordx4 v6, s[28:31], s74 offen offset:128 lds
  s_add_u32 m0, s100, 4992
  s_nop 0
  buffer_load_dwordx4 v5, s[28:31], s75 offen offset:128 lds
  s_add_u32 m0, s100, 7040
  s_nop 0
  buffer_load_dwordx4 v6, s[28:31], s75 offen offset:128 lds
  s_add_u32 m0, s101, 896
  s_nop 0
  buffer_load_dwordx4 v5, s[28:31], s76 offen offset:128 lds
  s_add_u32 m0, s101, 2944
  s_nop 0
  buffer_load_dwordx4 v6, s[28:31], s76 offen offset:128 lds
  s_add_u32 s62, s62, 1
  s_and_b32 s62, s62, 3
  s_lshl_b32 s56, s62, 18
  s_add_u32 s56, s56, s54
  buffer_load_dwordx4 v[136:139], v4, s[32:35], s56 offen
  s_add_u32 s56, s56, 8192
  buffer_load_dwordx4 v[140:143], v4, s[32:35], s56 offen
  s_add_u32 s56, s56, 8192
  buffer_load_dwordx4 v[144:147], v4, s[32:35], s56 offen
  s_add_u32 s56, s56, 8192
  buffer_load_dwordx4 v[148:151], v4, s[32:35], s56 offen
  s_add_u32 s56, s56, 8192
  buffer_load_dwordx4 v[152:155], v4, s[32:35], s56 offen
  s_add_u32 s56, s56, 8192
  buffer_load_dwordx4 v[156:159], v4, s[32:35], s56 offen
  s_add_u32 s56, s56, 8192
  buffer_load_dwordx4 v[160:163], v4, s[32:35], s56 offen
  s_add_u32 s56, s56, 8192
  buffer_load_dwordx4 v[164:167], v4, s[32:35], s56 offen
  s_add_u32 s62, s62, 1
  s_and_b32 s62, s62, 3
  s_lshl_b32 s56, s62, 18
  s_add_u32 s56, s56, s54
  buffer_load_dwordx4 v[168:171], v4, s[32:35], s56 offen
  s_add_u32 s56, s56, 8192
  buffer_load_dwordx4 v[172:175], v4, s[32:35], s56 offen
  s_add_u32 s56, s56, 8192
  buffer_load_dwordx4 v[176:179], v4, s[32:35], s56 offen
  s_add_u32 s56, s56, 8192
  buffer_load_dwordx4 v[180:183], v4, s[32:35], s56 offen
  s_add_u32 s56, s56, 8192
  buffer_load_dwordx4 v[184:187], v4, s[32:35], s56 offen
  s_add_u32 s56, s56, 8192
  buffer_load_dwordx4 v[188:191], v4, s[32:35], s56 offen
  s_add_u32 s56, s56, 8192
  buffer_load_dwordx4 v[192:195], v4, s[32:35], s56 offen
  s_add_u32 s56, s56, 8192
  buffer_load_dwordx4 v[196:199], v4, s[32:35], s56 offen
  s_lshl_b32 s58, s48, 5
  v_mov_b32 v0, 0
  s_cmp_lg_u32 s53, 3
  s_cbranch_scc1 L_QA_NOANNLD
  buffer_load_dwordx2 v[254:255], v0, s[40:43], s58 offen sc1
L_QA_NOANNLD:
  s_add_u32 s62, s62, 1
  s_and_b32 s62, s62, 3
  s_lshl_b32 s56, s62, 18
  s_add_u32 s56, s56, s54
  buffer_load_dwordx4 v[200:203], v4, s[32:35], s56 offen
  s_add_u32 s56, s56, 8192
  buffer_load_dwordx4 v[204:207], v4, s[32:35], s56 offen
  s_add_u32 s56, s56, 8192
  buffer_load_dwordx4 v[208:211], v4, s[32:35], s56 offen
  s_add_u32 s56, s56, 8192
  buffer_load_dwordx4 v[212:215], v4, s[32:35], s56 offen
  s_add_u32 s56, s56, 8192
  buffer_load_dwordx4 v[216:219], v4, s[32:35], s56 offen
  s_add_u32 s56, s56, 8192
  buffer_load_dwordx4 v[220:223], v4, s[32:35], s56 offen
  s_add_u32 s56, s56, 8192
  buffer_load_dwordx4 v[224:227], v4, s[32:35], s56 offen
  s_add_u32 s56, s56, 8192
  buffer_load_dwordx4 v[228:231], v4, s[32:35], s56 offen
  v_lshrrev_b32 v8, 3, v3
  v_lshlrev_b32 v9, 1, v8
  v_xor_b32 v9, v9, v2
  v_lshlrev_b32 v9, 4, v9
  v_lshl_add_u32 v9, v8, 11, v9
  v_and_b32 v8, 7, v3
  v_lshl_add_u32 v7, v8, 6, v9
  v_add_u32 v252, s100, v7
  v_add_u32 v253, s101, v7
  s_add_u32 s62, s62, 1
  s_and_b32 s62, s62, 3
  s_lshl_b32 s56, s62, 9
  v_add_u32 v7, s56, v252
  v_add_u32 v5, s56, v253
  s_waitcnt vmcnt(24)
  ds_read_b128 v[232:235], v7 offset:0
  ds_read_b128 v[236:239], v7 offset:4096
  ds_read_b128 v[240:243], v5 offset:0
  v_lshlrev_b32 v6, 4, v1
  s_waitcnt vmcnt(24)
  s_add_u32 s62, s62, 1
  s_and_b32 s62, s62, 3
  s_lshl_b32 s56, s62, 9
  v_add_u32 v7, s56, v252
  v_add_u32 v5, s56, v253
  v_perm_b32 v244, v108, v104, s70
  v_perm_b32 v245, v116, v112, s70
  v_perm_b32 v246, v124, v120, s70
  v_perm_b32 v247, v132, v128, s70
  s_waitcnt lgkmcnt(0)
  s_nop 0
  v_mfma_f32_16x16x32_bf16 v[8:11], v[244:247], v[232:235], 0
  v_perm_b32 v248, v108, v104, s71
  v_perm_b32 v249, v116, v112, s71
  v_mfma_f32_16x16x32_bf16 v[40:43], v[244:247], v[236:239], 0
  v_perm_b32 v250, v124, v120, s71
  v_perm_b32 v251, v132, v128, s71
  v_mfma_f32_16x16x32_bf16 v[72:75], v[244:247], v[240:243], 0
  s_nop 0
  v_mfma_f32_16x16x32_bf16 v[12:15], v[248:251], v[232:235], 0
  v_perm_b32 v244, v109, v105, s70
  v_perm_b32 v245, v117, v113, s70
  v_mfma_f32_16x16x32_bf16 v[44:47], v[248:251], v[236:239], 0
  v_perm_b32 v246, v125, v121, s70
  v_perm_b32 v247, v133, v129, s70
  v_mfma_f32_16x16x32_bf16 v[76:79], v[248:251], v[240:243], 0
  s_nop 0
  v_mfma_f32_16x16x32_bf16 v[16:19], v[244:247], v[232:235], 0
  v_perm_b32 v248, v109, v105, s71
  v_perm_b32 v249, v117, v113, s71
  v_mfma_f32_16x16x32_bf16 v[48:51], v[244:247], v[236:239], 0
  v_perm_b32 v250, v125, v121, s71
  v_perm_b32 v251, v133, v129, s71
  v_mfma_f32_16x16x32_bf16 v[80:83], v[244:247], v[240:243], 0
  s_nop 0
  v_mfma_f32_16x16x32_bf16 v[20:23], v[248:251], v[232:235], 0
  v_perm_b32 v244, v110, v106, s70
  v_perm_b32 v245, v118, v114, s70
  v_mfma_f32_16x16x32_bf16 v[52:55], v[248:251], v[236:239], 0
  v_perm_b32 v246, v126, v122, s70
  v_perm_b32 v247, v134, v130, s70
  v_mfma_f32_16x16x32_bf16 v[84:87], v[248:251], v[240:243], 0
  s_nop 0
  v_mfma_f32_16x16x32_bf16 v[24:27], v[244:247], v[232:235], 0
  v_perm_b32 v248, v110, v106, s71
  v_perm_b32 v249, v118, v114, s71
  v_mfma_f32_16x16x32_bf16 v[56:59], v[244:247], v[236:239], 0
  v_perm_b32 v250, v126, v122, s71
  v_perm_b32 v251, v134, v130, s71
  v_mfma_f32_16x16x32_bf16 v[88:91], v[244:247], v[240:243], 0
  s_nop 0
  v_mfma_f32_16x16x32_bf16 v[28:31], v[248:251], v[232:235], 0
  v_perm_b32 v244, v111, v107, s70
  v_perm_b32 v245, v119, v115, s70
  v_mfma_f32_16x16x32_bf16 v[60:63], v[248:251], v[236:239], 0
  v_perm_b32 v246, v127, v123, s70
  v_perm_b32 v247, v135, v131, s70
  v_mfma_f32_16x16x32_bf16 v[92:95], v[248:251], v[240:243], 0
  s_nop 0
  v_mfma_f32_16x16x32_bf16 v[32:35], v[244:247], v[232:235], 0
  v_perm_b32 v248, v111, v107, s71
  v_perm_b32 v249, v119, v115, s71
  v_mfma_f32_16x16x32_bf16 v[64:67], v[244:247], v[236:239], 0
  v_perm_b32 v250, v127, v123, s71
  v_perm_b32 v251, v135, v131, s71
  v_mfma_f32_16x16x32_bf16 v[96:99], v[244:247], v[240:243], 0
  s_nop 0
  v_mfma_f32_16x16x32_bf16 v[36:39], v[248:251], v[232:235], 0
  ds_read_b128 v[232:235], v7 offset:0
  v_mfma_f32_16x16x32_bf16 v[68:71], v[248:251], v[236:239], 0
  ds_read_b128 v[236:239], v7 offset:4096
  v_mfma_f32_16x16x32_bf16 v[100:103], v[248:251], v[240:243], 0
  ds_read_b128 v[240:243], v5 offset:0
  s_waitcnt vmcnt(16)
  s_add_u32 s62, s62, 1
  s_and_b32 s62, s62, 3
  s_lshl_b32 s56, s62, 9
  v_add_u32 v7, s56, v252
  v_add_u32 v5, s56, v253
  v_perm_b32 v244, v140, v136, s70
  v_perm_b32 v245, v148, v144, s70
  v_perm_b32 v246, v156, v152, s70
  v_perm_b32 v247, v164, v160, s70
  s_waitcnt lgkmcnt(0)
  s_nop 0
  v_mfma_f32_16x16x32_bf16 v[8:11], v[244:247], v[232:235], v[8:11]
  v_perm_b32 v248, v140, v136, s71
  v_perm_b32 v249, v148, v144, s71
  v_mfma_f32_16x16x32_bf16 v[40:43], v[244:247], v[236:239], v[40:43]
  v_perm_b32 v250, v156, v152, s71
  v_perm_b32 v251, v164, v160, s71
  v_mfma_f32_16x16x32_bf16 v[72:75], v[244:247], v[240:243], v[72:75]
  s_nop 0
  v_mfma_f32_16x16x32_bf16 v[12:15], v[248:251], v[232:235], v[12:15]
  v_perm_b32 v244, v141, v137, s70
  v_perm_b32 v245, v149, v145, s70
  v_mfma_f32_16x16x32_bf16 v[44:47], v[248:251], v[236:239], v[44:47]
  v_perm_b32 v246, v157, v153, s70
  v_perm_b32 v247, v165, v161, s70
  v_mfma_f32_16x16x32_bf16 v[76:79], v[248:251], v[240:243], v[76:79]
  s_nop 0
  v_mfma_f32_16x16x32_bf16 v[16:19], v[244:247], v[232:235], v[16:19]
  v_perm_b32 v248, v141, v137, s71
  v_perm_b32 v249, v149, v145, s71
  v_mfma_f32_16x16x32_bf16 v[48:51], v[244:247], v[236:239], v[48:51]
  v_perm_b32 v250, v157, v153, s71
  v_perm_b32 v251, v165, v161, s71
  v_mfma_f32_16x16x32_bf16 v[80:83], v[244:247], v[240:243], v[80:83]
  s_nop 0
  v_mfma_f32_16x16x32_bf16 v[20:23], v[248:251], v[232:235], v[20:23]
  v_perm_b32 v244, v142, v138, s70
  v_perm_b32 v245, v150, v146, s70
  v_mfma_f32_16x16x32_bf16 v[52:55], v[248:251], v[236:239], v[52:55]
  v_perm_b32 v246, v158, v154, s70
  v_perm_b32 v247, v166, v162, s70
  v_mfma_f32_16x16x32_bf16 v[84:87], v[248:251], v[240:243], v[84:87]
  s_nop 0
  v_mfma_f32_16x16x32_bf16 v[24:27], v[244:247], v[232:235], v[24:27]
  v_perm_b32 v248, v142, v138, s71
  v_perm_b32 v249, v150, v146, s71
  v_mfma_f32_16x16x32_bf16 v[56:59], v[244:247], v[236:239], v[56:59]
  v_perm_b32 v250, v158, v154, s71
  v_perm_b32 v251, v166, v162, s71
  v_mfma_f32_16x16x32_bf16 v[88:91], v[244:247], v[240:243], v[88:91]
  s_nop 0
  v_mfma_f32_16x16x32_bf16 v[28:31], v[248:251], v[232:235], v[28:31]
  v_perm_b32 v244, v143, v139, s70
  v_perm_b32 v245, v151, v147, s70
  v_mfma_f32_16x16x32_bf16 v[60:63], v[248:251], v[236:239], v[60:63]
  v_perm_b32 v246, v159, v155, s70
  v_perm_b32 v247, v167, v163, s70
  v_mfma_f32_16x16x32_bf16 v[92:95], v[248:251], v[240:243], v[92:95]
  s_nop 0
  v_mfma_f32_16x16x32_bf16 v[32:35], v[244:247], v[232:235], v[32:35]
  v_perm_b32 v248, v143, v139, s71
  v_perm_b32 v249, v151, v147, s71
  v_mfma_f32_16x16x32_bf16 v[64:67], v[244:247], v[236:239], v[64:67]
  v_perm_b32 v250, v159, v155, s71
  v_perm_b32 v251, v167, v163, s71
  v_mfma_f32_16x16x32_bf16 v[96:99], v[244:247], v[240:243], v[96:99]
  s_nop 0
  v_mfma_f32_16x16x32_bf16 v[36:39], v[248:251], v[232:235], v[36:39]
  ds_read_b128 v[232:235], v7 offset:0
  v_mfma_f32_16x16x32_bf16 v[68:71], v[248:251], v[236:239], v[68:71]
  ds_read_b128 v[236:239], v7 offset:4096
  v_mfma_f32_16x16x32_bf16 v[100:103], v[248:251], v[240:243], v[100:103]
  ds_read_b128 v[240:243], v5 offset:0
  s_waitcnt vmcnt(8)
  s_add_u32 s62, s62, 1
  s_and_b32 s62, s62, 3
  s_lshl_b32 s56, s62, 9
  v_add_u32 v7, s56, v252
  v_add_u32 v5, s56, v253
  v_perm_b32 v244, v172, v168, s70
  v_perm_b32 v245, v180, v176, s70
  v_perm_b32 v246, v188, v184, s70
  v_perm_b32 v247, v196, v192, s70
  s_waitcnt lgkmcnt(0)
  s_nop 0
  v_mfma_f32_16x16x32_bf16 v[8:11], v[244:247], v[232:235], v[8:11]
  v_perm_b32 v248, v172, v168, s71
  v_perm_b32 v249, v180, v176, s71
  v_mfma_f32_16x16x32_bf16 v[40:43], v[244:247], v[236:239], v[40:43]
  v_perm_b32 v250, v188, v184, s71
  v_perm_b32 v251, v196, v192, s71
  v_mfma_f32_16x16x32_bf16 v[72:75], v[244:247], v[240:243], v[72:75]
  s_nop 0
  v_mfma_f32_16x16x32_bf16 v[12:15], v[248:251], v[232:235], v[12:15]
  v_perm_b32 v244, v173, v169, s70
  v_perm_b32 v245, v181, v177, s70
  v_mfma_f32_16x16x32_bf16 v[44:47], v[248:251], v[236:239], v[44:47]
  v_perm_b32 v246, v189, v185, s70
  v_perm_b32 v247, v197, v193, s70
  v_mfma_f32_16x16x32_bf16 v[76:79], v[248:251], v[240:243], v[76:79]
  s_nop 0
  v_mfma_f32_16x16x32_bf16 v[16:19], v[244:247], v[232:235], v[16:19]
  v_perm_b32 v248, v173, v169, s71
  v_perm_b32 v249, v181, v177, s71
  v_mfma_f32_16x16x32_bf16 v[48:51], v[244:247], v[236:239], v[48:51]
  v_perm_b32 v250, v189, v185, s71
  v_perm_b32 v251, v197, v193, s71
  v_mfma_f32_16x16x32_bf16 v[80:83], v[244:247], v[240:243], v[80:83]
  s_nop 0
  v_mfma_f32_16x16x32_bf16 v[20:23], v[248:251], v[232:235], v[20:23]
  v_perm_b32 v244, v174, v170, s70
  v_perm_b32 v245, v182, v178, s70
  v_mfma_f32_16x16x32_bf16 v[52:55], v[248:251], v[236:239], v[52:55]
  v_perm_b32 v246, v190, v186, s70
  v_perm_b32 v247, v198, v194, s70
  v_mfma_f32_16x16x32_bf16 v[84:87], v[248:251], v[240:243], v[84:87]
  s_nop 0
  v_mfma_f32_16x16x32_bf16 v[24:27], v[244:247], v[232:235], v[24:27]
  v_perm_b32 v248, v174, v170, s71
  v_perm_b32 v249, v182, v178, s71
  v_mfma_f32_16x16x32_bf16 v[56:59], v[244:247], v[236:239], v[56:59]
  v_perm_b32 v250, v190, v186, s71
  v_perm_b32 v251, v198, v194, s71
  v_mfma_f32_16x16x32_bf16 v[88:91], v[244:247], v[240:243], v[88:91]
  s_nop 0
  v_mfma_f32_16x16x32_bf16 v[28:31], v[248:251], v[232:235], v[28:31]
  v_perm_b32 v244, v175, v171, s70
  v_perm_b32 v245, v183, v179, s70
  v_mfma_f32_16x16x32_bf16 v[60:63], v[248:251], v[236:239], v[60:63]
  v_perm_b32 v246, v191, v187, s70
  v_perm_b32 v247, v199, v195, s70
  v_mfma_f32_16x16x32_bf16 v[92:95], v[248:251], v[240:243], v[92:95]
  s_nop 0
  v_mfma_f32_16x16x32_bf16 v[32:35], v[244:247], v[232:235], v[32:35]
  v_perm_b32 v248, v175, v171, s71
  v_perm_b32 v249, v183, v179, s71
  v_mfma_f32_16x16x32_bf16 v[64:67], v[244:247], v[236:239], v[64:67]
  v_perm_b32 v250, v191, v187, s71
  v_perm_b32 v251, v199, v195, s71
  v_mfma_f32_16x16x32_bf16 v[96:99], v[244:247], v[240:243], v[96:99]
  s_nop 0
  v_mfma_f32_16x16x32_bf16 v[36:39], v[248:251], v[232:235], v[36:39]
  ds_read_b128 v[232:235], v7 offset:0
  v_mfma_f32_16x16x32_bf16 v[68:71], v[248:251], v[236:239], v[68:71]
  ds_read_b128 v[236:239], v7 offset:4096
  v_mfma_f32_16x16x32_bf16 v[100:103], v[248:251], v[240:243], v[100:103]
  ds_read_b128 v[240:243], v5 offset:0
  s_waitcnt vmcnt(0)
  v_add_u32 v4, s100, v6
  v_add_u32 v5, s101, v6
  v_add_u32 v7, 0xE000, v6
  v_perm_b32 v244, v204, v200, s70
  v_perm_b32 v245, v212, v208, s70
  v_perm_b32 v246, v220, v216, s70
  v_perm_b32 v247, v228, v224, s70
  s_waitcnt lgkmcnt(0)
  s_nop 0
  v_mfma_f32_16x16x32_bf16 v[8:11], v[244:247], v[232:235], v[8:11]
  v_perm_b32 v248, v204, v200, s71
  v_perm_b32 v249, v212, v208, s71
  v_mfma_f32_16x16x32_bf16 v[40:43], v[244:247], v[236:239], v[40:43]
  v_perm_b32 v250, v220, v216, s71
  v_perm_b32 v251, v228, v224, s71
  v_mfma_f32_16x16x32_bf16 v[72:75], v[244:247], v[240:243], v[72:75]
  s_nop 0
  v_mfma_f32_16x16x32_bf16 v[12:15], v[248:251], v[232:235], v[12:15]
  v_perm_b32 v244, v205, v201, s70
  v_perm_b32 v245, v213, v209, s70
  v_mfma_f32_16x16x32_bf16 v[44:47], v[248:251], v[236:239], v[44:47]
  v_perm_b32 v246, v221, v217, s70
  v_perm_b32 v247, v229, v225, s70
  v_mfma_f32_16x16x32_bf16 v[76:79], v[248:251], v[240:243], v[76:79]
  s_nop 0
  v_mfma_f32_16x16x32_bf16 v[16:19], v[244:247], v[232:235], v[16:19]
  v_perm_b32 v248, v205, v201, s71
  v_perm_b32 v249, v213, v209, s71
  v_mfma_f32_16x16x32_bf16 v[48:51], v[244:247], v[236:239], v[48:51]
  v_perm_b32 v250, v221, v217, s71
  v_perm_b32 v251, v229, v225, s71
  v_mfma_f32_16x16x32_bf16 v[80:83], v[244:247], v[240:243], v[80:83]
  ds_write_b128 v4, v[40:43] offset:0
  ds_write_b128 v5, v[72:75] offset:0
  v_mfma_f32_16x16x32_bf16 v[20:23], v[248:251], v[232:235], v[20:23]
  v_perm_b32 v244, v206, v202, s70
  v_perm_b32 v245, v214, v210, s70
  v_mfma_f32_16x16x32_bf16 v[52:55], v[248:251], v[236:239], v[52:55]
  v_perm_b32 v246, v222, v218, s70
  v_perm_b32 v247, v230, v226, s70
  v_mfma_f32_16x16x32_bf16 v[84:87], v[248:251], v[240:243], v[84:87]
  ds_write_b128 v4, v[44:47] offset:1024
  ds_write_b128 v5, v[76:79] offset:1024
  v_mfma_f32_16x16x32_bf16 v[24:27], v[244:247], v[232:235], v[24:27]
  v_perm_b32 v248, v206, v202, s71
  v_perm_b32 v249, v214, v210, s71
  v_mfma_f32_16x16x32_bf16 v[56:59], v[244:247], v[236:239], v[56:59]
  v_perm_b32 v250, v222, v218, s71
  v_perm_b32 v251, v230, v226, s71
  v_mfma_f32_16x16x32_bf16 v[88:91], v[244:247], v[240:243], v[88:91]
  ds_write_b128 v4, v[48:51] offset:2048
  ds_write_b128 v5, v[80:83] offset:2048
  v_mfma_f32_16x16x32_bf16 v[28:31], v[248:251], v[232:235], v[28:31]
  v_perm_b32 v244, v207, v203, s70
  v_perm_b32 v245, v215, v211, s70
  v_mfma_f32_16x16x32_bf16 v[60:63], v[248:251], v[236:239], v[60:63]
  v_perm_b32 v246, v223, v219, s70
  v_perm_b32 v247, v231, v227, s70
  v_mfma_f32_16x16x32_bf16 v[92:95], v[248:251], v[240:243], v[92:95]
  ds_write_b128 v4, v[52:55] offset:3072
  ds_write_b128 v5, v[84:87] offset:3072
  v_mfma_f32_16x16x32_bf16 v[32:35], v[244:247], v[232:235], v[32:35]
  v_perm_b32 v248, v207, v203, s71
  v_perm_b32 v249, v215, v211, s71
  v_mfma_f32_16x16x32_bf16 v[64:67], v[244:247], v[236:239], v[64:67]
  v_perm_b32 v250, v223, v219, s71
  v_perm_b32 v251, v231, v227, s71
  v_mfma_f32_16x16x32_bf16 v[96:99], v[244:247], v[240:243], v[96:99]
  ds_write_b128 v4, v[56:59] offset:4096
  ds_write_b128 v5, v[88:91] offset:4096
  v_mfma_f32_16x16x32_bf16 v[36:39], v[248:251], v[232:235], v[36:39]
  v_mfma_f32_16x16x32_bf16 v[68:71], v[248:251], v[236:239], v[68:71]
  v_mfma_f32_16x16x32_bf16 v[100:103], v[248:251], v[240:243], v[100:103]
  ds_write_b128 v4, v[60:63] offset:5120
  ds_write_b128 v5, v[92:95] offset:5120
  s_nop 3
  ds_write_b128 v4, v[64:67] offset:6144
  ds_write_b128 v5, v[96:99] offset:6144
  s_nop 1
  ds_write_b128 v4, v[68:71] offset:7168
  ds_write_b128 v5, v[100:103] offset:7168
  s_cmp_lg_u32 s53, 3
  s_cbranch_scc1 L_QA_WDONE
  ds_write_b128 v7, v[8:11] offset:0
  ds_write_b128 v7, v[12:15] offset:1024
  ds_write_b128 v7, v[16:19] offset:2048
  ds_write_b128 v7, v[20:23] offset:3072
  ds_write_b128 v7, v[24:27] offset:4096
  ds_write_b128 v7, v[28:31] offset:5120
  ds_write_b128 v7, v[32:35] offset:6144
  ds_write_b128 v7, v[36:39] offset:7168
  s_mov_b32 s69, 0
L_QA_ANN:
  s_waitcnt vmcnt(0)
  v_readfirstlane_b32 s59, v254
  s_add_u32 s69, s69, 1
  s_cmp_lg_u32 s59, 0
  s_cbranch_scc1 L_QA_ANNOK
  s_cmp_ge_u32 s69, 100000
  s_cbranch_scc1 L_QA_ANNOK
  s_sleep 4
  buffer_load_dwordx2 v[254:255], v0, s[40:43], s58 offen sc1
  s_branch L_QA_ANN
L_QA_ANNOK:
  v_mov_b32 v4, 0x27800
  ds_write_b64 v4, v[254:255] offset:16
L_QA_WDONE:
  v_mov_b32 v4, 0x27800
  v_mov_b32 v5, 1
  s_waitcnt lgkmcnt(0)
  s_mov_b64 exec, 1
  ds_add_u32 v4, v5
  s_mov_b64 exec, -1
  s_cmp_eq_u32 s53, 3
  s_cbranch_scc1 L_QA_PUBDONE
  s_mov_b32 s69, 0
L_QA_SPIN:
  ds_read_b32 v7, v4 offset:0
  s_add_u32 s69, s69, 1
  s_waitcnt lgkmcnt(0)
  v_readfirstlane_b32 s58, v7
  s_cmp_ge_u32 s69, 1000000
  s_cbranch_scc1 L_QA_SPIN_GO
  s_cmp_ge_u32 s58, 4
  s_cbranch_scc1 L_QA_SPIN_GO
  s_branch L_QA_SPIN
L_QA_SPIN_GO:
  s_mov_b32 s59, 0xA000
  s_cmp_eq_u32 s53, 1
  s_cselect_b32 s59, 0x1A000, s59
  s_cmp_eq_u32 s53, 2
  s_cselect_b32 s59, 0x20000, s59
  v_add_u32 v7, s59, v6
  ds_read_b64 v[254:255], v4 offset:16
  ds_read_b128 v[104:107], v7 offset:0
  ds_read_b128 v[108:111], v7 offset:1024
  ds_read_b128 v[112:115], v7 offset:2048
  ds_read_b128 v[116:119], v7 offset:3072
  ds_read_b128 v[120:123], v7 offset:4096
  ds_read_b128 v[124:127], v7 offset:5120
  ds_read_b128 v[128:131], v7 offset:6144
  ds_read_b128 v[132:135], v7 offset:7168
  ds_read_b128 v[136:139], v7 offset:8192
  ds_read_b128 v[140:143], v7 offset:9216
  ds_read_b128 v[144:147], v7 offset:10240
  ds_read_b128 v[148:151], v7 offset:11264
  ds_read_b128 v[152:155], v7 offset:12288
  ds_read_b128 v[156:159], v7 offset:13312
  ds_read_b128 v[160:163], v7 offset:14336
  ds_read_b128 v[164:167], v7 offset:15360
  ds_read_b128 v[168:171], v7 offset:16384
  ds_read_b128 v[172:175], v7 offset:17408
  ds_read_b128 v[176:179], v7 offset:18432
  ds_read_b128 v[180:183], v7 offset:19456
  ds_read_b128 v[184:187], v7 offset:20480
  ds_read_b128 v[188:191], v7 offset:21504
  ds_read_b128 v[192:195], v7 offset:22528
  ds_read_b128 v[196:199], v7 offset:23552
  s_mov_b32 s80, 0x3e0293ee
  s_mov_b32 s81, 0x3e0293ee
  s_mul_i32 s58, s77, 12288
  s_lshl_b32 s59, s53, 12
  s_add_u32 s58, s58, s59
  v_lshlrev_b32 v7, 4, v3
  v_lshl_add_u32 v7, v2, 10, v7
  s_waitcnt lgkmcnt(15)
  v_pk_add_f32 v[8:9], v[8:9], v[104:105]
  v_pk_add_f32 v[10:11], v[10:11], v[106:107]
  v_pk_add_f32 v[12:13], v[12:13], v[108:109]
  v_pk_add_f32 v[14:15], v[14:15], v[110:111]
  v_pk_add_f32 v[16:17], v[16:17], v[112:113]
  v_pk_add_f32 v[18:19], v[18:19], v[114:115]
  v_pk_add_f32 v[20:21], v[20:21], v[116:117]
  v_pk_add_f32 v[22:23], v[22:23], v[118:119]
  v_pk_add_f32 v[24:25], v[24:25], v[120:121]
  v_pk_add_f32 v[26:27], v[26:27], v[122:123]
  v_pk_add_f32 v[28:29], v[28:29], v[124:125]
  v_pk_add_f32 v[30:31], v[30:31], v[126:127]
  v_pk_add_f32 v[32:33], v[32:33], v[128:129]
  v_pk_add_f32 v[34:35], v[34:35], v[130:131]
  v_pk_add_f32 v[36:37], v[36:37], v[132:133]
  v_pk_add_f32 v[38:39], v[38:39], v[134:135]
  s_waitcnt lgkmcnt(8)
  v_pk_add_f32 v[8:9], v[8:9], v[136:137]
  v_pk_add_f32 v[10:11], v[10:11], v[138:139]
  v_pk_add_f32 v[12:13], v[12:13], v[140:141]
  v_pk_add_f32 v[14:15], v[14:15], v[142:143]
  v_pk_add_f32 v[16:17], v[16:17], v[144:145]
  v_pk_add_f32 v[18:19], v[18:19], v[146:147]
  v_pk_add_f32 v[20:21], v[20:21], v[148:149]
  v_pk_add_f32 v[22:23], v[22:23], v[150:151]
  v_pk_add_f32 v[24:25], v[24:25], v[152:153]
  v_pk_add_f32 v[26:27], v[26:27], v[154:155]
  v_pk_add_f32 v[28:29], v[28:29], v[156:157]
  v_pk_add_f32 v[30:31], v[30:31], v[158:159]
  v_pk_add_f32 v[32:33], v[32:33], v[160:161]
  v_pk_add_f32 v[34:35], v[34:35], v[162:163]
  v_pk_add_f32 v[36:37], v[36:37], v[164:165]
  v_pk_add_f32 v[38:39], v[38:39], v[166:167]
  s_waitcnt lgkmcnt(0)
  v_pk_add_f32 v[8:9], v[8:9], v[168:169]
  v_pk_add_f32 v[10:11], v[10:11], v[170:171]
  v_pk_add_f32 v[12:13], v[12:13], v[172:173]
  v_pk_add_f32 v[14:15], v[14:15], v[174:175]
  v_pk_add_f32 v[16:17], v[16:17], v[176:177]
  v_pk_add_f32 v[18:19], v[18:19], v[178:179]
  v_pk_add_f32 v[20:21], v[20:21], v[180:181]
  v_pk_add_f32 v[22:23], v[22:23], v[182:183]
  v_pk_add_f32 v[24:25], v[24:25], v[184:185]
  v_pk_add_f32 v[26:27], v[26:27], v[186:187]
  v_pk_add_f32 v[28:29], v[28:29], v[188:189]
  v_pk_add_f32 v[30:31], v[30:31], v[190:191]
  v_pk_add_f32 v[32:33], v[32:33], v[192:193]
  v_pk_add_f32 v[34:35], v[34:35], v[194:195]
  v_pk_add_f32 v[36:37], v[36:37], v[196:197]
  v_pk_add_f32 v[38:39], v[38:39], v[198:199]
  s_mov_b64 exec, 1
  ds_add_u32 v4, v5 offset:12
  s_mov_b64 exec, -1
  v_pk_mul_f32 v[8:9], v[8:9], s[80:81]
  v_pk_mul_f32 v[10:11], v[10:11], s[80:81]
  v_pk_mul_f32 v[12:13], v[12:13], s[80:81]
  v_pk_mul_f32 v[14:15], v[14:15], s[80:81]
  v_pk_mul_f32 v[16:17], v[16:17], s[80:81]
  v_pk_mul_f32 v[18:19], v[18:19], s[80:81]
  v_pk_mul_f32 v[20:21], v[20:21], s[80:81]
  v_pk_mul_f32 v[22:23], v[22:23], s[80:81]
  v_pk_mul_f32 v[24:25], v[24:25], s[80:81]
  v_pk_mul_f32 v[26:27], v[26:27], s[80:81]
  v_pk_mul_f32 v[28:29], v[28:29], s[80:81]
  v_pk_mul_f32 v[30:31], v[30:31], s[80:81]
  v_pk_mul_f32 v[32:33], v[32:33], s[80:81]
  v_pk_mul_f32 v[34:35], v[34:35], s[80:81]
  v_pk_mul_f32 v[36:37], v[36:37], s[80:81]
  v_pk_mul_f32 v[38:39], v[38:39], s[80:81]
  v_cvt_pk_bf16_f32 v104, v8, v12
  v_cvt_pk_bf16_f32 v105, v16, v20
  v_cvt_pk_bf16_f32 v106, v24, v28
  v_cvt_pk_bf16_f32 v107, v32, v36
  buffer_store_dwordx4 v[104:107], v7, s[44:47], s58 offen offset:0
  v_cvt_pk_bf16_f32 v108, v9, v13
  v_cvt_pk_bf16_f32 v109, v17, v21
  v_cvt_pk_bf16_f32 v110, v25, v29
  v_cvt_pk_bf16_f32 v111, v33, v37
  buffer_store_dwordx4 v[108:111], v7, s[44:47], s58 offen offset:256
  v_cvt_pk_bf16_f32 v112, v10, v14
  v_cvt_pk_bf16_f32 v113, v18, v22
  v_cvt_pk_bf16_f32 v114, v26, v30
  v_cvt_pk_bf16_f32 v115, v34, v38
  buffer_store_dwordx4 v[112:115], v7, s[44:47], s58 offen offset:512
  v_cvt_pk_bf16_f32 v116, v11, v15
  v_cvt_pk_bf16_f32 v117, v19, v23
  v_cvt_pk_bf16_f32 v118, v27, v31
  v_cvt_pk_bf16_f32 v119, v35, v39
  buffer_store_dwordx4 v[116:119], v7, s[44:47], s58 offen offset:768
  s_getreg_b32 s59, hwreg(HW_REG_XCC_ID)
  s_and_b32 s59, s59, 7
  s_lshl_b32 s59, s59, 1
  v_or_b32 v8, s59, v254
  v_mov_b32 v9, v255
  s_waitcnt vmcnt(0)
  s_mov_b64 exec, 1
  ds_add_rtn_u32 v7, v4, v5 offset:4
  s_waitcnt lgkmcnt(0)
  v_readfirstlane_b32 s58, v7
  s_cmp_lg_u32 s58, 2
  s_cbranch_scc1 L_QA_NOFLAG
  s_lshl_b32 s58, s77, 10
  s_add_u32 s58, s58, 0x1600000
  buffer_store_dwordx2 v[8:9], v0, s[44:47], s58 offen
L_QA_NOFLAG:
  s_mov_b64 exec, -1
L_QA_PUBDONE:
  v_readfirstlane_b32 s74, v254
  v_readfirstlane_b32 s75, v255
  s_getreg_b32 s59, hwreg(HW_REG_XCC_ID)
  s_and_b32 s59, s59, 7
  s_lshl_b32 s59, s59, 1
  s_or_b32 s76, s74, s59
  s_andn2_b32 s57, s77, 3
  s_add_u32 s57, s57, s53
  s_lshl_b32 s58, s57, 10
  s_add_u32 s58, s58, 0x1600000
  v_lshlrev_b32 v7, 7, v1
  v_mov_b32 v8, s74
  v_mov_b32 v9, s75
  v_writelane_b32 v8, s76, 0
  s_mov_b32 s69, 0
L_QA_POLL:
  s_mov_b64 exec, 3
  buffer_load_dwordx2 v[4:5], v7, s[44:47], s58 offen sc1
  s_add_u32 s69, s69, 1
  s_waitcnt vmcnt(0)
  v_cmp_eq_u64 vcc, v[4:5], v[8:9]
  s_mov_b64 exec, -1
  s_cmp_eq_u32 s69, 40
  s_cbranch_vccnz L_QA_SEEN
  s_cbranch_scc1 L_QA_SLOWPUB
  s_cmp_ge_u32 s69, 100000
  s_cbranch_scc1 L_QA_SEEN
  s_sleep 1
  s_branch L_QA_POLL
L_QA_SEEN:
  s_and_b32 s59, vcc_lo, 1
  s_cmp_gt_u32 s69, 40
  s_cselect_b32 s54, 1, s59
  s_cmp_eq_u32 s54, 0
  s_cbranch_scc1 L_QA_SLOWPUB
  s_mul_i32 s58, s57, 12288
  s_cmp_eq_u32 s59, 0
  s_cselect_b32 s54, 0x300000, 0
  s_add_u32 s58, s58, s54
  buffer_load_dwordx4 v[136:139], v6, s[44:47], s58 offen offset:0 sc1
  buffer_load_dwordx4 v[140:143], v6, s[44:47], s58 offen offset:1024 sc1
  buffer_load_dwordx4 v[144:147], v6, s[44:47], s58 offen offset:2048 sc1
  buffer_load_dwordx4 v[148:151], v6, s[44:47], s58 offen offset:3072 sc1
  s_add_u32 s58, s58, 4096
  buffer_load_dwordx4 v[152:155], v6, s[44:47], s58 offen offset:0 sc1
  buffer_load_dwordx4 v[156:159], v6, s[44:47], s58 offen offset:1024 sc1
  buffer_load_dwordx4 v[160:163], v6, s[44:47], s58 offen offset:2048 sc1
  buffer_load_dwordx4 v[164:167], v6, s[44:47], s58 offen offset:3072 sc1
  s_add_u32 s58, s58, 4096
  buffer_load_dwordx4 v[168:171], v6, s[44:47], s58 offen offset:0 sc1
  buffer_load_dwordx4 v[172:175], v6, s[44:47], s58 offen offset:1024 sc1
  buffer_load_dwordx4 v[176:179], v6, s[44:47], s58 offen offset:2048 sc1
  buffer_load_dwordx4 v[180:183], v6, s[44:47], s58 offen offset:3072 sc1
  s_mov_b32 s65, s59
  s_lshl_b32 s54, s53, 2
  s_add_u32 s54, s54, 0x27820
  v_mov_b32 v4, s54
  v_mov_b32 v5, s59
  ds_write_b32 v4, v5
  v_lshrrev_b32 v4, 3, v3
  v_lshlrev_b32 v5, 1, v4
  v_xor_b32 v5, v5, v2
  v_lshlrev_b32 v5, 4, v5
  v_lshl_add_u32 v5, v4, 11, v5
  v_and_b32 v4, 7, v3
  v_lshl_add_u32 v130, v4, 6, v5
  v_mov_b32 v124, v130
  s_mul_i32 s58, s53, 6144
  s_add_u32 s58, s58, 0x20000
  v_add_u32 v125, s58, v6
  s_mul_i32 s58, s53, 1536
  s_add_u32 s58, s58, 0x26000
  v_lshlrev_b32 v4, 2, v1
  v_add_u32 v126, s58, v4
  s_mov_b32 s64, 0
  s_lshl_b32 s58, s77, 2
  s_add_u32 s58, s58, s53
  s_lshl_b32 s59, s58, 9
  s_add_u32 s59, s59, 0x1200000
  v_lshlrev_b32 v121, 3, v1
  v_lshlrev_b32 v121, 6, v1
  s_mul_i32 s58, s58, 12288
  s_add_u32 s58, s58, 0x600000
  s_add_u32 s59, s58, 8192
  s_setprio 1
  s_waitcnt lgkmcnt(0)
  s_barrier
  ds_read_b128 v[8:11], v124 offset:0
  ds_read_b128 v[12:15], v124 offset:512
  ds_read_b128 v[16:19], v124 offset:1024
  ds_read_b128 v[20:23], v124 offset:1536
  ds_read_b128 v[24:27], v124 offset:4096
  ds_read_b128 v[28:31], v124 offset:4608
  ds_read_b128 v[32:35], v124 offset:5120
  ds_read_b128 v[36:39], v124 offset:5632
  s_waitcnt vmcnt(0) lgkmcnt(0)
  v_mfma_f32_16x16x32_bf16 v[80:83], v[8:11], v[152:155], 0
  v_mfma_f32_16x16x32_bf16 v[80:83], v[12:15], v[156:159], v[80:83]
  v_mfma_f32_16x16x32_bf16 v[80:83], v[16:19], v[160:163], v[80:83]
  v_mfma_f32_16x16x32_bf16 v[80:83], v[20:23], v[164:167], v[80:83]
  v_mfma_f32_16x16x32_bf16 v[88:91], v[8:11], v[168:171], 0
  v_mfma_f32_16x16x32_bf16 v[88:91], v[12:15], v[172:175], v[88:91]
  v_mfma_f32_16x16x32_bf16 v[88:91], v[16:19], v[176:179], v[88:91]
  v_mfma_f32_16x16x32_bf16 v[88:91], v[20:23], v[180:183], v[88:91]
  v_mfma_f32_16x16x32_bf16 v[72:75], v[8:11], v[136:139], 0
  v_mfma_f32_16x16x32_bf16 v[72:75], v[12:15], v[140:143], v[72:75]
  v_mfma_f32_16x16x32_bf16 v[72:75], v[16:19], v[144:147], v[72:75]
  v_mfma_f32_16x16x32_bf16 v[72:75], v[20:23], v[148:151], v[72:75]
  v_mfma_f32_16x16x32_bf16 v[76:79], v[24:27], v[136:139], 0
  v_max3_f32 v108, v80, v81, v82
  v_max_f32 v108, v108, v83
  v_mov_b32 v109, v108
  s_nop 1
  v_mfma_f32_16x16x32_bf16 v[76:79], v[28:31], v[140:143], v[76:79]
  v_permlane32_swap_b32 v108, v109
  v_max_f32 v108, v108, v109
  v_mov_b32 v109, v108
  s_nop 1
  v_mfma_f32_16x16x32_bf16 v[76:79], v[32:35], v[144:147], v[76:79]
  v_permlane16_swap_b32 v108, v109
  v_max_f32 v108, v108, v109
  v_sub_f32 v100, 0, v108
  v_sub_f32 v101, 0, v108
  v_mfma_f32_16x16x32_bf16 v[76:79], v[36:39], v[148:151], v[76:79]
  v_sub_f32 v102, 0, v108
  v_sub_f32 v103, 0, v108
  v_max3_f32 v127, v72, v73, v74
  v_max_f32 v127, v127, v75
  v_mov_b32 v128, v127
  s_nop 1
  v_permlane32_swap_b32 v127, v128
  v_max_f32 v127, v127, v128
  v_mov_b32 v128, v127
  s_nop 1
  v_permlane16_swap_b32 v127, v128
  v_max_f32 v127, v127, v128
  v_sub_f32 v96, 0, v127
  v_sub_f32 v97, 0, v127
  v_sub_f32 v98, 0, v127
  v_sub_f32 v99, 0, v127
  v_max3_f32 v110, v88, v89, v90
  v_max_f32 v110, v110, v91
  v_mov_b32 v111, v110
  s_nop 1
  v_permlane32_swap_b32 v110, v111
  v_max_f32 v110, v110, v111
  v_mov_b32 v111, v110
  s_nop 1
  v_permlane16_swap_b32 v110, v111
  v_max_f32 v110, v110, v111
  v_sub_f32 v104, 0, v110
  v_sub_f32 v105, 0, v110
  v_sub_f32 v106, 0, v110
  v_sub_f32 v107, 0, v110
  v_sub_f32 v72, v72, v127
  v_sub_f32 v73, v73, v127
  v_sub_f32 v74, v74, v127
  v_sub_f32 v75, v75, v127
  v_sub_f32 v76, v76, v127
  v_sub_f32 v77, v77, v127
  v_sub_f32 v78, v78, v127
  v_sub_f32 v79, v79, v127
  s_branch L_A_ENTRY
  .p2align 6
L_A_LOOP:
  s_waitcnt lgkmcnt(0)
  s_barrier
  ds_read_b128 v[40:43], v124 offset:8192
  v_mfma_f32_16x16x32_bf16 v[72:75], v[20:23], v[148:151], v[72:75]
  v_exp_f32 v92, v92
  v_exp_f32 v93, v93
  v_mfma_f32_16x16x32_bf16 v[76:79], v[24:27], v[136:139], v[96:99]
  v_exp_f32 v94, v94
  v_exp_f32 v95, v95
  v_mfma_f32_16x16x32_bf16 v[76:79], v[28:31], v[140:143], v[76:79]
  v_cvt_pk_bf16_f32 v118, v92, v93
  v_cvt_pk_bf16_f32 v119, v94, v95
  ds_read_b128 v[44:47], v124 offset:8704
  v_mfma_f32_16x16x32_bf16 v[76:79], v[32:35], v[144:147], v[76:79]
  ds_write_b128 v125, v[116:119] offset:5120
  v_mfma_f32_16x16x32_bf16 v[76:79], v[36:39], v[148:151], v[76:79]
  ds_read_b128 v[48:51], v124 offset:9216
  ds_read_b128 v[52:55], v124 offset:9728
L_A_ENTRY2:
  v_mfma_f32_16x16x32_bf16 v[80:83], v[8:11], v[152:155], v[100:103]
  v_exp_f32 v72, v72
  v_exp_f32 v73, v73
  v_mfma_f32_16x16x32_bf16 v[80:83], v[12:15], v[156:159], v[80:83]
  v_exp_f32 v74, v74
  v_exp_f32 v75, v75
  v_mfma_f32_16x16x32_bf16 v[80:83], v[16:19], v[160:163], v[80:83]
  v_cvt_pk_bf16_f32 v116, v72, v73
  v_cvt_pk_bf16_f32 v117, v74, v75
  ds_read_b128 v[56:59], v124 offset:12288
  v_mfma_f32_16x16x32_bf16 v[80:83], v[20:23], v[164:167], v[80:83]
  v_exp_f32 v76, v76
  v_exp_f32 v77, v77
  v_mfma_f32_16x16x32_bf16 v[84:87], v[24:27], v[152:155], v[100:103]
  v_exp_f32 v78, v78
  v_exp_f32 v79, v79
  v_mfma_f32_16x16x32_bf16 v[84:87], v[28:31], v[156:159], v[84:87]
  v_cvt_pk_bf16_f32 v118, v76, v77
  v_cvt_pk_bf16_f32 v119, v78, v79
  ds_read_b128 v[60:63], v124 offset:12800
  v_mfma_f32_16x16x32_bf16 v[84:87], v[32:35], v[160:163], v[84:87]
  ds_write_b128 v125, v[116:119] offset:0
  v_mfma_f32_16x16x32_bf16 v[84:87], v[36:39], v[164:167], v[84:87]
  ds_read_b128 v[64:67], v124 offset:13312
  ds_read_b128 v[68:71], v124 offset:13824
  v_add_u32 v124, 0x4000, v124
  v_and_b32 v124, 0xffff, v124
  v_mfma_f32_16x16x32_bf16 v[88:91], v[8:11], v[168:171], v[104:107]
  v_exp_f32 v80, v80
  v_exp_f32 v81, v81
  v_mfma_f32_16x16x32_bf16 v[88:91], v[12:15], v[172:175], v[88:91]
  v_exp_f32 v82, v82
  v_exp_f32 v83, v83
  v_mfma_f32_16x16x32_bf16 v[88:91], v[16:19], v[176:179], v[88:91]
  v_cvt_pk_bf16_f32 v116, v80, v81
  v_cvt_pk_bf16_f32 v117, v82, v83
  v_mfma_f32_16x16x32_bf16 v[88:91], v[20:23], v[180:183], v[88:91]
  v_exp_f32 v84, v84
  v_exp_f32 v85, v85
  v_mfma_f32_16x16x32_bf16 v[92:95], v[24:27], v[168:171], v[104:107]
  v_exp_f32 v86, v86
  v_exp_f32 v87, v87
  v_mfma_f32_16x16x32_bf16 v[92:95], v[28:31], v[172:175], v[92:95]
  v_cvt_pk_bf16_f32 v118, v84, v85
  v_cvt_pk_bf16_f32 v119, v86, v87
  v_mfma_f32_16x16x32_bf16 v[92:95], v[32:35], v[176:179], v[92:95]
  ds_write_b128 v125, v[116:119] offset:1024
  v_mfma_f32_16x16x32_bf16 v[92:95], v[36:39], v[180:183], v[92:95]
  s_waitcnt lgkmcnt(1)
  v_mfma_f32_16x16x32_bf16 v[72:75], v[40:43], v[136:139], v[96:99]
  v_exp_f32 v88, v88
  v_exp_f32 v89, v89
  v_mfma_f32_16x16x32_bf16 v[72:75], v[44:47], v[140:143], v[72:75]
  v_exp_f32 v90, v90
  v_exp_f32 v91, v91
  v_mfma_f32_16x16x32_bf16 v[72:75], v[48:51], v[144:147], v[72:75]
  v_cvt_pk_bf16_f32 v116, v88, v89
  v_cvt_pk_bf16_f32 v117, v90, v91
  s_waitcnt lgkmcnt(0)
  s_barrier
  ds_read_b128 v[8:11], v124 offset:0
  v_mfma_f32_16x16x32_bf16 v[72:75], v[52:55], v[148:151], v[72:75]
  v_exp_f32 v92, v92
  v_exp_f32 v93, v93
  v_mfma_f32_16x16x32_bf16 v[76:79], v[56:59], v[136:139], v[96:99]
  v_exp_f32 v94, v94
  v_exp_f32 v95, v95
  v_mfma_f32_16x16x32_bf16 v[76:79], v[60:63], v[140:143], v[76:79]
  v_cvt_pk_bf16_f32 v118, v92, v93
  v_cvt_pk_bf16_f32 v119, v94, v95
  ds_read_b128 v[12:15], v124 offset:512
  v_mfma_f32_16x16x32_bf16 v[76:79], v[64:67], v[144:147], v[76:79]
  ds_write_b128 v125, v[116:119] offset:2048
  v_mfma_f32_16x16x32_bf16 v[76:79], v[68:71], v[148:151], v[76:79]
  ds_read_b128 v[16:19], v124 offset:1024
  ds_read_b128 v[20:23], v124 offset:1536
  v_mfma_f32_16x16x32_bf16 v[80:83], v[40:43], v[152:155], v[100:103]
  v_exp_f32 v72, v72
  v_exp_f32 v73, v73
  v_mfma_f32_16x16x32_bf16 v[80:83], v[44:47], v[156:159], v[80:83]
  v_exp_f32 v74, v74
  v_exp_f32 v75, v75
  v_mfma_f32_16x16x32_bf16 v[80:83], v[48:51], v[160:163], v[80:83]
  v_cvt_pk_bf16_f32 v116, v72, v73
  v_cvt_pk_bf16_f32 v117, v74, v75
  ds_read_b128 v[24:27], v124 offset:4096
  v_mfma_f32_16x16x32_bf16 v[80:83], v[52:55], v[164:167], v[80:83]
  v_exp_f32 v76, v76
  v_exp_f32 v77, v77
  v_mfma_f32_16x16x32_bf16 v[84:87], v[56:59], v[152:155], v[100:103]
  v_exp_f32 v78, v78
  v_exp_f32 v79, v79
  v_mfma_f32_16x16x32_bf16 v[84:87], v[60:63], v[156:159], v[84:87]
  v_cvt_pk_bf16_f32 v118, v76, v77
  v_cvt_pk_bf16_f32 v119, v78, v79
  ds_read_b128 v[28:31], v124 offset:4608
  v_mfma_f32_16x16x32_bf16 v[84:87], v[64:67], v[160:163], v[84:87]
  ds_write_b128 v125, v[116:119] offset:3072
  v_mfma_f32_16x16x32_bf16 v[84:87], v[68:71], v[164:167], v[84:87]
  ds_read_b128 v[32:35], v124 offset:5120
  ds_read_b128 v[36:39], v124 offset:5632
  v_mfma_f32_16x16x32_bf16 v[88:91], v[40:43], v[168:171], v[104:107]
  v_exp_f32 v80, v80
  v_exp_f32 v81, v81
  v_mfma_f32_16x16x32_bf16 v[88:91], v[44:47], v[172:175], v[88:91]
  v_exp_f32 v82, v82
  v_exp_f32 v83, v83
  v_mfma_f32_16x16x32_bf16 v[88:91], v[48:51], v[176:179], v[88:91]
  v_cvt_pk_bf16_f32 v116, v80, v81
  v_cvt_pk_bf16_f32 v117, v82, v83
  v_mfma_f32_16x16x32_bf16 v[88:91], v[52:55], v[180:183], v[88:91]
  v_exp_f32 v84, v84
  v_exp_f32 v85, v85
  v_mfma_f32_16x16x32_bf16 v[92:95], v[56:59], v[168:171], v[104:107]
  v_exp_f32 v86, v86
  v_exp_f32 v87, v87
  v_mfma_f32_16x16x32_bf16 v[92:95], v[60:63], v[172:175], v[92:95]
  v_cvt_pk_bf16_f32 v118, v84, v85
  v_cvt_pk_bf16_f32 v119, v86, v87
  v_mfma_f32_16x16x32_bf16 v[92:95], v[64:67], v[176:179], v[92:95]
  ds_write_b128 v125, v[116:119] offset:4096
  v_mfma_f32_16x16x32_bf16 v[92:95], v[68:71], v[180:183], v[92:95]
  s_add_u32 s64, s64, 1
  s_cmp_lt_u32 s64, 8
  s_waitcnt lgkmcnt(1)
  s_cbranch_scc0 L_A_LAST
  v_mfma_f32_16x16x32_bf16 v[72:75], v[8:11], v[136:139], v[96:99]
  v_exp_f32 v88, v88
  v_exp_f32 v89, v89
  v_mfma_f32_16x16x32_bf16 v[72:75], v[12:15], v[140:143], v[72:75]
  v_exp_f32 v90, v90
  v_exp_f32 v91, v91
  v_mfma_f32_16x16x32_bf16 v[72:75], v[16:19], v[144:147], v[72:75]
  v_cvt_pk_bf16_f32 v116, v88, v89
  v_cvt_pk_bf16_f32 v117, v90, v91
  s_branch L_A_LOOP
L_A_LAST:
  s_andn2_b32 s57, s77, 3
  s_add_u32 s57, s57, s53
  s_lshl_b32 s57, s57, 10
  s_add_u32 s57, s57, 0x1600000
  buffer_load_dwordx2 v[122:123], v0, s[44:47], s57 offen offset:8 sc1
  s_nop 7
  v_exp_f32 v88, v88
  v_exp_f32 v89, v89
  v_exp_f32 v90, v90
  v_exp_f32 v91, v91
  s_nop 0
  v_cvt_pk_bf16_f32 v116, v88, v89
  v_cvt_pk_bf16_f32 v117, v90, v91
  s_waitcnt lgkmcnt(0)
  s_barrier
  v_exp_f32 v92, v92
  v_exp_f32 v93, v93
  v_exp_f32 v94, v94
  v_exp_f32 v95, v95
  s_nop 0
  v_cvt_pk_bf16_f32 v118, v92, v93
  v_cvt_pk_bf16_f32 v119, v94, v95
  ds_write_b128 v125, v[116:119] offset:5120
L_A_FINISH:
  s_cmp_eq_u32 s65, 0
  s_cbranch_scc1 L_A_F1OK
  s_andn2_b32 s57, s77, 3
  s_add_u32 s57, s57, s53
  s_lshl_b32 s57, s57, 10
  s_add_u32 s57, s57, 0x1600000
  s_waitcnt vmcnt(0)
  v_cmp_ne_u64 vcc, s[74:75], v[122:123]
  s_cbranch_vccz L_A_F1OK
  s_mov_b64 exec, 0x1
  s_mov_b32 s69, 0
L_A_F1P:
  buffer_load_dwordx2 v[122:123], v0, s[44:47], s57 offen offset:8 sc1
  s_add_u32 s69, s69, 1
  s_waitcnt vmcnt(0)
  v_cmp_ne_u64 vcc, s[74:75], v[122:123]
  s_cmp_ge_u32 s69, 100000
  s_cbranch_scc1 L_A_F1P_OUT
  s_cbranch_vccz L_A_F1P_OUT
  s_mov_b64 exec, vcc
  s_sleep 1
  s_branch L_A_F1P
L_A_F1P_OUT:
  s_mov_b64 exec, -1
L_A_F1OK:
  s_mul_i32 s58, s53, 192
  s_add_u32 s58, s58, 0x27900
  v_lshl_add_u32 v4, v3, 2, s58
  ds_write_b32 v4, v96 offset:0
  ds_write_b32 v4, v100 offset:64
  ds_write_b32 v4, v104 offset:128
  s_waitcnt lgkmcnt(0)
  s_barrier
  s_setprio 0
  s_barrier
  v_mov_b32 v4, 0x27800
  ds_read_b32 v5, v4 offset:8
  s_waitcnt lgkmcnt(0)
  v_readfirstlane_b32 s54, v5
  s_cmp_lg_u32 s54, 0
  s_cbranch_scc0 L_TAIL
  s_cmp_lg_u32 s73, 0
  s_cbranch_scc1 L_TAIL
  s_branch L_A_SAFE
L_A_ENTRY:
  ds_read_b128 v[40:43], v124 offset:8192
  ds_read_b128 v[44:47], v124 offset:8704
  ds_read_b128 v[48:51], v124 offset:9216
  ds_read_b128 v[52:55], v124 offset:9728
  s_branch L_A_ENTRY2
L_QA_SLOWPUB:
  s_lshl_b32 s59, s77, 10
  s_add_u32 s59, s59, 0x1600000
  s_mov_b32 s54, 0
L_QA_OWN:
  buffer_load_dwordx2 v[4:5], v0, s[44:47], s59 offen sc1
  s_add_u32 s54, s54, 1
  s_waitcnt vmcnt(0)
  v_and_b32 v4, 0xfffffff1, v4
  v_cmp_ne_u64 vcc, s[74:75], v[4:5]
  s_cmp_ge_u32 s54, 100000
  s_cbranch_scc1 L_QA_OWNED
  s_cbranch_vccnz L_QA_OWN
L_QA_OWNED:
  s_mul_i32 s54, s77, 12288
  buffer_load_dwordx4 v[136:139], v6, s[44:47], s54 offen offset:0 sc1
  buffer_load_dwordx4 v[140:143], v6, s[44:47], s54 offen offset:1024 sc1
  buffer_load_dwordx4 v[144:147], v6, s[44:47], s54 offen offset:2048 sc1
  buffer_load_dwordx4 v[148:151], v6, s[44:47], s54 offen offset:3072 sc1
  s_add_u32 s54, s54, 4096
  buffer_load_dwordx4 v[152:155], v6, s[44:47], s54 offen offset:0 sc1
  buffer_load_dwordx4 v[156:159], v6, s[44:47], s54 offen offset:1024 sc1
  buffer_load_dwordx4 v[160:163], v6, s[44:47], s54 offen offset:2048 sc1
  buffer_load_dwordx4 v[164:167], v6, s[44:47], s54 offen offset:3072 sc1
  s_add_u32 s54, s54, 4096
  buffer_load_dwordx4 v[168:171], v6, s[44:47], s54 offen offset:0 sc1
  buffer_load_dwordx4 v[172:175], v6, s[44:47], s54 offen offset:1024 sc1
  buffer_load_dwordx4 v[176:179], v6, s[44:47], s54 offen offset:2048 sc1
  buffer_load_dwordx4 v[180:183], v6, s[44:47], s54 offen offset:3072 sc1
  s_add_u32 s54, s54, 4096
  s_add_u32 s54, s54, 0x2fd000
  s_waitcnt vmcnt(0)
  buffer_store_dwordx4 v[136:139], v6, s[44:47], s54 offen offset:0 sc1
  buffer_store_dwordx4 v[140:143], v6, s[44:47], s54 offen offset:1024 sc1
  buffer_store_dwordx4 v[144:147], v6, s[44:47], s54 offen offset:2048 sc1
  buffer_store_dwordx4 v[148:151], v6, s[44:47], s54 offen offset:3072 sc1
  s_add_u32 s54, s54, 4096
  buffer_store_dwordx4 v[152:155], v6, s[44:47], s54 offen offset:0 sc1
  buffer_store_dwordx4 v[156:159], v6, s[44:47], s54 offen offset:1024 sc1
  buffer_store_dwordx4 v[160:163], v6, s[44:47], s54 offen offset:2048 sc1
  buffer_store_dwordx4 v[164:167], v6, s[44:47], s54 offen offset:3072 sc1
  s_add_u32 s54, s54, 4096
  buffer_store_dwordx4 v[168:171], v6, s[44:47], s54 offen offset:0 sc1
  buffer_store_dwordx4 v[172:175], v6, s[44:47], s54 offen offset:1024 sc1
  buffer_store_dwordx4 v[176:179], v6, s[44:47], s54 offen offset:2048 sc1
  buffer_store_dwordx4 v[180:183], v6, s[44:47], s54 offen offset:3072 sc1
  s_add_u32 s54, s54, 4096
  v_mov_b32 v4, s74
  v_mov_b32 v5, s75
  s_waitcnt vmcnt(0)
  s_mov_b64 exec, 1
  buffer_store_dwordx2 v[4:5], v0, s[44:47], s59 offen offset:128 sc1
  s_mov_b64 exec, -1
  s_mov_b32 s69, 40
  s_branch L_QA_POLL
  .p2align 6
L_B_START:
  v_lshlrev_b32 v4, 7, v1
  s_mul_i32 s54, s77, 12288
  s_lshl_b32 s55, s53, 12
  s_add_u32 s54, s54, s55
  s_cmp_ge_u32 s53, 2
  s_cbranch_scc1 L_B_NOTOUCH
  buffer_load_dword v212, v4, s[44:47], s54 offen sc1
L_B_NOTOUCH:
  v_lshrrev_b32 v4, 2, v1
  v_and_b32 v4, 7, v4
  v_lshrrev_b32 v5, 5, v1
  v_and_b32 v6, 3, v1
  s_and_b32 s54, s53, 1
  s_lshl_b32 s54, s54, 1
  v_xor_b32 v7, s54, v6
  v_lshl_add_u32 v7, v5, 2, v7
  v_lshlrev_b32 v7, 4, v7
  v_lshl_add_u32 v208, v4, 8, v7
  v_lshrrev_b32 v7, 2, v4
  v_lshlrev_b32 v7, 1, v7
  v_xor_b32 v7, v7, v6
  v_lshl_add_u32 v7, v5, 2, v7
  v_lshlrev_b32 v7, 4, v7
  v_lshl_add_u32 v209, v4, 8, v7
  v_lshl_add_u32 v186, v4, 10, v7
  v_mov_b32 v184, v208
  v_mov_b32 v185, v209
  s_lshl_b32 s65, s51, 19
  s_lshl_b32 s54, s50, 17
  s_add_u32 s65, s65, s54
  s_lshl_b32 s54, s53, 11
  s_add_u32 s65, s65, s54
  s_mov_b32 s66, s65
  s_add_u32 s67, s54, 0x0
  s_add_u32 s68, s54, 0x10000
  s_mov_b32 s72, 8
  s_movk_i32 s70, 0x2000
  s_movk_i32 s71, 0x2000
  s_mov_b32 m0, s67
  s_nop 0
  buffer_load_dwordx4 v184, s[20:23], s65 offen nt lds
  s_add_u32 m0, s67, 896
  s_add_u32 s67, s67, 8192
  buffer_load_dwordx4 v184, s[20:23], s65 offen offset:128 nt lds
  s_add_u32 s65, s65, s70
  s_bitset0_b32 s67, 16
  s_mov_b32 m0, s67
  s_nop 0
  buffer_load_dwordx4 v184, s[20:23], s65 offen nt lds
  s_add_u32 m0, s67, 896
  s_add_u32 s67, s67, 8192
  buffer_load_dwordx4 v184, s[20:23], s65 offen offset:128 nt lds
  s_add_u32 s65, s65, s70
  s_bitset0_b32 s67, 16
  v_lshrrev_b32 v5, 1, v2
  v_and_b32 v6, 1, v2
  v_lshrrev_b32 v7, 2, v3
  v_lshl_add_u32 v7, v6, 2, v7
  v_lshlrev_b32 v7, 6, v7
  v_lshl_add_u32 v7, v5, 11, v7
  v_and_b32 v5, 3, v3
  v_lshl_add_u32 v7, v5, 3, v7
  v_add_u32 v7, 0x10000, v7
  v_lshl_add_u32 v210, v6, 5, v7
  v_lshlrev_b32 v6, 4, v1
  s_mul_i32 s58, s53, 6144
  s_add_u32 s58, s58, 0x20000
  v_add_u32 v189, s58, v6
  s_mul_i32 s58, s53, 1536
  s_add_u32 s58, s58, 0x26000
  v_lshlrev_b32 v5, 2, v1
  v_add_u32 v190, s58, v5
  v_mov_b32 v204, 0x3f803f80
  v_mov_b32 v205, 0x3f803f80
  v_mov_b32 v206, 0x3f803f80
  v_mov_b32 v207, 0x3f803f80
  v_mov_b32 v187, v210
  v_xor_b32 v188, 32, v210
  v_mov_b32 v8, 0
  v_mov_b32 v9, 0
  v_mov_b32 v10, 0
  v_mov_b32 v11, 0
  v_mov_b32 v12, 0
  v_mov_b32 v13, 0
  v_mov_b32 v14, 0
  v_mov_b32 v15, 0
  v_mov_b32 v16, 0
  v_mov_b32 v17, 0
  v_mov_b32 v18, 0
  v_mov_b32 v19, 0
  v_mov_b32 v20, 0
  v_mov_b32 v21, 0
  v_mov_b32 v22, 0
  v_mov_b32 v23, 0
  v_mov_b32 v24, 0
  v_mov_b32 v25, 0
  v_mov_b32 v26, 0
  v_mov_b32 v27, 0
  v_mov_b32 v28, 0
  v_mov_b32 v29, 0
  v_mov_b32 v30, 0
  v_mov_b32 v31, 0
  v_mov_b32 v32, 0
  v_mov_b32 v33, 0
  v_mov_b32 v34, 0
  v_mov_b32 v35, 0
  v_mov_b32 v36, 0
  v_mov_b32 v37, 0
  v_mov_b32 v38, 0
  v_mov_b32 v39, 0
  v_mov_b32 v40, 0
  v_mov_b32 v41, 0
  v_mov_b32 v42, 0
  v_mov_b32 v43, 0
  v_mov_b32 v44, 0
  v_mov_b32 v45, 0
  v_mov_b32 v46, 0
  v_mov_b32 v47, 0
  v_mov_b32 v48, 0
  v_mov_b32 v49, 0
  v_mov_b32 v50, 0
  v_mov_b32 v51, 0
  v_mov_b32 v52, 0
  v_mov_b32 v53, 0
  v_mov_b32 v54, 0
  v_mov_b32 v55, 0
  v_mov_b32 v56, 0
  v_mov_b32 v57, 0
  v_mov_b32 v58, 0
  v_mov_b32 v59, 0
  v_mov_b32 v60, 0
  v_mov_b32 v61, 0
  v_mov_b32 v62, 0
  v_mov_b32 v63, 0
  v_mov_b32 v64, 0
  v_mov_b32 v65, 0
  v_mov_b32 v66, 0
  v_mov_b32 v67, 0
  v_mov_b32 v68, 0
  v_mov_b32 v69, 0
  v_mov_b32 v70, 0
  v_mov_b32 v71, 0
  v_mov_b32 v72, 0
  v_mov_b32 v73, 0
  v_mov_b32 v74, 0
  v_mov_b32 v75, 0
  v_mov_b32 v76, 0
  v_mov_b32 v77, 0
  v_mov_b32 v78, 0
  v_mov_b32 v79, 0
  v_mov_b32 v80, 0
  v_mov_b32 v81, 0
  v_mov_b32 v82, 0
  v_mov_b32 v83, 0
  v_mov_b32 v84, 0
  v_mov_b32 v85, 0
  v_mov_b32 v86, 0
  v_mov_b32 v87, 0
  v_mov_b32 v88, 0
  v_mov_b32 v89, 0
  v_mov_b32 v90, 0
  v_mov_b32 v91, 0
  v_mov_b32 v92, 0
  v_mov_b32 v93, 0
  v_mov_b32 v94, 0
  v_mov_b32 v95, 0
  v_mov_b32 v96, 0
  v_mov_b32 v97, 0
  v_mov_b32 v98, 0
  v_mov_b32 v99, 0
  v_mov_b32 v100, 0
  v_mov_b32 v101, 0
  v_mov_b32 v102, 0
  v_mov_b32 v103, 0
  v_mov_b32 v192, 0
  v_mov_b32 v193, 0
  v_mov_b32 v194, 0
  v_mov_b32 v195, 0
  v_mov_b32 v196, 0
  v_mov_b32 v197, 0
  v_mov_b32 v198, 0
  v_mov_b32 v199, 0
  v_mov_b32 v200, 0
  v_mov_b32 v201, 0
  v_mov_b32 v202, 0
  v_mov_b32 v203, 0
  s_waitcnt vmcnt(2)
  s_mov_b32 m0, s67
  s_nop 0
  buffer_load_dwordx4 v184, s[20:23], s65 offen nt lds
  s_add_u32 m0, s67, 896
  s_add_u32 s67, s67, 8192
  buffer_load_dwordx4 v184, s[20:23], s65 offen offset:128 nt lds
  s_add_u32 s65, s65, s70
  s_bitset0_b32 s67, 16
  s_waitcnt vmcnt(2)
  s_mov_b32 m0, s68
  s_nop 0
  buffer_load_dwordx4 v185, s[24:27], s66 offen nt lds
  s_add_u32 m0, s68, 896
  s_add_u32 s68, s68, 8192
  buffer_load_dwordx4 v185, s[24:27], s66 offen offset:128 nt lds
  s_add_u32 s66, s66, s71
  s_bitset1_b32 s68, 16
  s_bitset0_b32 s68, 17
  s_waitcnt vmcnt(2)
  s_mov_b32 m0, s67
  s_nop 0
  buffer_load_dwordx4 v184, s[20:23], s65 offen nt lds
  s_add_u32 m0, s67, 896
  s_add_u32 s67, s67, 8192
  buffer_load_dwordx4 v184, s[20:23], s65 offen offset:128 nt lds
  s_add_u32 s65, s65, s70
  s_bitset0_b32 s67, 16
  s_waitcnt vmcnt(2)
  s_mov_b32 m0, s68
  s_nop 0
  buffer_load_dwordx4 v185, s[24:27], s66 offen nt lds
  s_add_u32 m0, s68, 896
  s_add_u32 s68, s68, 8192
  buffer_load_dwordx4 v185, s[24:27], s66 offen offset:128 nt lds
  s_add_u32 s66, s66, s71
  s_bitset1_b32 s68, 16
  s_bitset0_b32 s68, 17
  s_waitcnt vmcnt(2)
  s_mov_b32 m0, s67
  s_nop 0
  buffer_load_dwordx4 v184, s[20:23], s65 offen nt lds
  s_add_u32 m0, s67, 896
  s_add_u32 s67, s67, 8192
  buffer_load_dwordx4 v184, s[20:23], s65 offen offset:128 nt lds
  s_add_u32 s65, s65, s70
  s_bitset0_b32 s67, 16
  s_waitcnt vmcnt(2)
  s_mov_b32 m0, s68
  s_nop 0
  buffer_load_dwordx4 v185, s[24:27], s66 offen nt lds
  s_add_u32 m0, s68, 896
  s_add_u32 s68, s68, 8192
  buffer_load_dwordx4 v185, s[24:27], s66 offen offset:128 nt lds
  s_add_u32 s66, s66, s71
  s_bitset1_b32 s68, 16
  s_bitset0_b32 s68, 17
  s_waitcnt vmcnt(2)
  s_mov_b32 m0, s68
  s_nop 0
  buffer_load_dwordx4 v185, s[24:27], s66 offen nt lds
  s_add_u32 m0, s68, 896
  s_add_u32 s68, s68, 8192
  buffer_load_dwordx4 v185, s[24:27], s66 offen offset:128 nt lds
  s_add_u32 s66, s66, s71
  s_bitset1_b32 s68, 16
  s_bitset0_b32 s68, 17
  s_waitcnt vmcnt(2)
  s_mov_b32 m0, s68
  s_nop 0
  buffer_load_dwordx4 v185, s[24:27], s66 offen nt lds
  s_add_u32 m0, s68, 896
  s_add_u32 s68, s68, 8192
  buffer_load_dwordx4 v185, s[24:27], s66 offen offset:128 nt lds
  s_add_u32 s66, s66, s71
  s_bitset1_b32 s68, 16
  s_bitset0_b32 s68, 17
  s_waitcnt vmcnt(12)
  s_barrier
  s_mov_b32 m0, s67
  s_nop 0
  buffer_load_dwordx4 v184, s[20:23], s65 offen nt lds
  s_add_u32 m0, s67, 896
  s_add_u32 s67, s67, 8192
  buffer_load_dwordx4 v184, s[20:23], s65 offen offset:128 nt lds
  s_add_u32 s65, s65, s70
  s_bitset0_b32 s67, 16
  s_mov_b32 m0, s67
  s_nop 0
  buffer_load_dwordx4 v184, s[20:23], s65 offen nt lds
  s_add_u32 m0, s67, 896
  s_add_u32 s67, s67, 8192
  buffer_load_dwordx4 v184, s[20:23], s65 offen offset:128 nt lds
  s_add_u32 s65, s65, s70
  s_bitset0_b32 s67, 16
  s_mov_b32 m0, s67
  s_nop 0
  buffer_load_dwordx4 v184, s[20:23], s65 offen nt lds
  s_add_u32 m0, s67, 896
  s_add_u32 s67, s67, 8192
  buffer_load_dwordx4 v184, s[20:23], s65 offen offset:128 nt lds
  s_add_u32 s65, s65, s70
  s_bitset0_b32 s67, 16
  s_mov_b32 m0, s68
  s_nop 0
  buffer_load_dwordx4 v185, s[24:27], s66 offen nt lds
  s_add_u32 m0, s68, 896
  s_add_u32 s68, s68, 8192
  buffer_load_dwordx4 v185, s[24:27], s66 offen offset:128 nt lds
  s_add_u32 s66, s66, s71
  s_bitset1_b32 s68, 16
  s_bitset0_b32 s68, 17
  v_mov_b32 v4, 0x27800
  ds_read_b64 v[6:7], v4 offset:16
  ds_read_b128 v[228:231], v4 offset:32
  s_mov_b32 s59, 0xffff
  v_mov_b32 v211, 0x10000
  s_waitcnt lgkmcnt(0)
  v_readfirstlane_b32 s74, v6
  v_readfirstlane_b32 s75, v7
  v_lshl_or_b32 v5, v229, 1, v228
  v_lshl_or_b32 v5, v230, 2, v5
  v_lshl_or_b32 v5, v231, 3, v5
  s_nop 0
  v_readfirstlane_b32 s62, v5
  s_mov_b32 m0, s67
  s_nop 0
  buffer_load_dwordx4 v184, s[20:23], s65 offen nt lds
  s_add_u32 m0, s67, 896
  s_add_u32 s67, s67, 8192
  buffer_load_dwordx4 v184, s[20:23], s65 offen offset:128 nt lds
  s_add_u32 s65, s65, s70
  s_bitset0_b32 s67, 16
  s_mov_b32 m0, s68
  s_nop 0
  buffer_load_dwordx4 v185, s[24:27], s66 offen nt lds
  s_add_u32 m0, s68, 896
  s_add_u32 s68, s68, 8192
  buffer_load_dwordx4 v185, s[24:27], s66 offen offset:128 nt lds
  s_add_u32 s66, s66, s71
  s_bitset1_b32 s68, 16
  s_bitset0_b32 s68, 17
  s_waitcnt vmcnt(20)
  s_barrier
  s_cmp_lg_u32 s53, 0
  s_cbranch_scc1 L_B_NOF1B
  s_lshl_b32 s54, s77, 10
  s_add_u32 s54, s54, 0x1600000
  v_mov_b32 v4, 0
  v_mov_b32 v6, s74
  v_mov_b32 v7, s75
  s_mov_b64 exec, 1
  buffer_store_dwordx2 v[6:7], v4, s[44:47], s54 offen offset:8
  s_mov_b64 exec, -1
L_B_NOF1B:
  ds_read_b128 v[176:179], v189 offset:0
  ds_read_b128 v[168:171], v189 offset:1024
  ds_read_b64_tr_b16 v[104:105], v187 offset:0
  ds_read_b64_tr_b16 v[106:107], v187 offset:4096
  ds_read_b64_tr_b16 v[108:109], v188 offset:0
  ds_read_b64_tr_b16 v[110:111], v188 offset:4096
  ds_read_b64_tr_b16 v[112:113], v187 offset:512
  ds_read_b64_tr_b16 v[114:115], v187 offset:4608
  ds_read_b64_tr_b16 v[116:117], v188 offset:512
  ds_read_b64_tr_b16 v[118:119], v188 offset:4608
  ds_read_b64_tr_b16 v[120:121], v187 offset:1024
  ds_read_b64_tr_b16 v[122:123], v187 offset:5120
  ds_read_b64_tr_b16 v[124:125], v188 offset:1024
  ds_read_b64_tr_b16 v[126:127], v188 offset:5120
  ds_read_b64_tr_b16 v[128:129], v187 offset:1536
  ds_read_b64_tr_b16 v[130:131], v187 offset:5632
  ds_read_b64_tr_b16 v[132:133], v188 offset:1536
  ds_read_b64_tr_b16 v[134:135], v188 offset:5632
  s_mov_b32 m0, s67
  s_nop 0
  buffer_load_dwordx4 v184, s[20:23], s65 offen nt lds
  s_add_u32 m0, s67, 896
  s_add_u32 s67, s67, 8192
  buffer_load_dwordx4 v184, s[20:23], s65 offen offset:128 nt lds
  s_add_u32 s65, s65, s70
  s_bitset0_b32 s67, 16
  s_mov_b32 m0, s68
  s_nop 0
  buffer_load_dwordx4 v185, s[24:27], s66 offen nt lds
  s_add_u32 m0, s68, 896
  s_add_u32 s68, s68, 8192
  buffer_load_dwordx4 v185, s[24:27], s66 offen offset:128 nt lds
  s_add_u32 s66, s66, s71
  s_bitset1_b32 s68, 16
  s_bitset0_b32 s68, 17
  s_waitcnt lgkmcnt(0)
  v_mfma_f32_16x16x32_bf16 v[192:195], v[204:207], v[176:179], v[192:195]
  ds_read_b64_tr_b16 v[136:137], v187 offset:8192
  v_mfma_f32_16x16x32_bf16 v[8:11], v[104:107], v[176:179], v[8:11]
  ds_read_b64_tr_b16 v[138:139], v187 offset:12288
  v_mfma_f32_16x16x32_bf16 v[12:15], v[108:111], v[176:179], v[12:15]
  ds_read_b64_tr_b16 v[140:141], v188 offset:8192
  v_mfma_f32_16x16x32_bf16 v[16:19], v[112:115], v[176:179], v[16:19]
  ds_read_b64_tr_b16 v[142:143], v188 offset:12288
  v_mfma_f32_16x16x32_bf16 v[20:23], v[116:119], v[176:179], v[20:23]
  ds_read_b64_tr_b16 v[144:145], v187 offset:8704
  v_mfma_f32_16x16x32_bf16 v[24:27], v[120:123], v[176:179], v[24:27]
  ds_read_b64_tr_b16 v[146:147], v187 offset:12800
  v_mfma_f32_16x16x32_bf16 v[28:31], v[124:127], v[176:179], v[28:31]
  v_mfma_f32_16x16x32_bf16 v[32:35], v[128:131], v[176:179], v[32:35]
  v_mfma_f32_16x16x32_bf16 v[36:39], v[132:135], v[176:179], v[36:39]
  s_mov_b32 s64, 2
  .p2align 6
L_B_LOOPF1:
  s_waitcnt vmcnt(20)
  s_barrier
  v_mfma_f32_16x16x32_bf16 v[196:199], v[204:207], v[168:171], v[196:199]
  ds_read_b128 v[172:175], v189 offset:2048
  ds_read_b128 v[176:179], v189 offset:3072
  v_mfma_f32_16x16x32_bf16 v[40:43], v[104:107], v[168:171], v[40:43]
  ds_read_b128 v[180:183], v189 offset:4096
  ds_read_b64_tr_b16 v[148:149], v188 offset:8704
  v_mfma_f32_16x16x32_bf16 v[44:47], v[108:111], v[168:171], v[44:47]
  s_mov_b32 m0, s67
  v_mfma_f32_16x16x32_bf16 v[48:51], v[112:115], v[168:171], v[48:51]
  buffer_load_dwordx4 v184, s[20:23], s65 offen nt lds
  v_mfma_f32_16x16x32_bf16 v[52:55], v[116:119], v[168:171], v[52:55]
  s_add_u32 m0, s67, 896
  s_add_u32 s67, s67, 8192
  v_mfma_f32_16x16x32_bf16 v[56:59], v[120:123], v[168:171], v[56:59]
  ds_read_b64_tr_b16 v[150:151], v188 offset:12800
  ds_read_b64_tr_b16 v[152:153], v187 offset:9216
  v_mfma_f32_16x16x32_bf16 v[60:63], v[124:127], v[168:171], v[60:63]
  ds_read_b64_tr_b16 v[154:155], v187 offset:13312
  ds_read_b64_tr_b16 v[156:157], v188 offset:9216
  v_mfma_f32_16x16x32_bf16 v[64:67], v[128:131], v[168:171], v[64:67]
  v_mfma_f32_16x16x32_bf16 v[68:71], v[132:135], v[168:171], v[68:71]
  s_waitcnt lgkmcnt(5)
  v_mfma_f32_16x16x32_bf16 v[200:203], v[204:207], v[172:175], v[200:203]
  ds_read_b64_tr_b16 v[158:159], v188 offset:13312
  ds_read_b64_tr_b16 v[160:161], v187 offset:9728
  v_mfma_f32_16x16x32_bf16 v[72:75], v[104:107], v[172:175], v[72:75]
  v_mfma_f32_16x16x32_bf16 v[76:79], v[108:111], v[172:175], v[76:79]
  buffer_load_dwordx4 v184, s[20:23], s65 offen offset:128 nt lds
  v_mfma_f32_16x16x32_bf16 v[80:83], v[112:115], v[172:175], v[80:83]
  s_add_u32 s65, s65, s70
  s_bitset0_b32 s67, 16
  s_mov_b32 m0, s68
  v_mfma_f32_16x16x32_bf16 v[84:87], v[116:119], v[172:175], v[84:87]
  ds_read_b64_tr_b16 v[162:163], v187 offset:13824
  ds_read_b64_tr_b16 v[164:165], v188 offset:9728
  v_mfma_f32_16x16x32_bf16 v[88:91], v[120:123], v[172:175], v[88:91]
  ds_read_b64_tr_b16 v[166:167], v188 offset:13824
  v_mfma_f32_16x16x32_bf16 v[92:95], v[124:127], v[172:175], v[92:95]
  v_mfma_f32_16x16x32_bf16 v[96:99], v[128:131], v[172:175], v[96:99]
  v_add_u32 v187, 0x4000, v187
  v_and_or_b32 v187, v187, s59, v211
  v_xor_b32 v188, 32, v187
  v_mfma_f32_16x16x32_bf16 v[100:103], v[132:135], v[172:175], v[100:103]
  buffer_load_dwordx4 v185, s[24:27], s66 offen nt lds
  s_waitcnt lgkmcnt(0)
  v_mfma_f32_16x16x32_bf16 v[192:195], v[204:207], v[176:179], v[192:195]
  s_add_u32 m0, s68, 896
  s_add_u32 s68, s68, 8192
  v_mfma_f32_16x16x32_bf16 v[8:11], v[136:139], v[176:179], v[8:11]
  buffer_load_dwordx4 v185, s[24:27], s66 offen offset:128 nt lds
  v_mfma_f32_16x16x32_bf16 v[12:15], v[140:143], v[176:179], v[12:15]
  s_add_u32 s66, s66, s71
  s_bitset1_b32 s68, 16
  s_bitset0_b32 s68, 17
  v_mfma_f32_16x16x32_bf16 v[16:19], v[144:147], v[176:179], v[16:19]
  ds_read_b64_tr_b16 v[104:105], v187 offset:0
  ds_read_b64_tr_b16 v[106:107], v187 offset:4096
  v_mfma_f32_16x16x32_bf16 v[20:23], v[148:151], v[176:179], v[20:23]
  ds_read_b64_tr_b16 v[108:109], v188 offset:0
  ds_read_b64_tr_b16 v[110:111], v188 offset:4096
  v_mfma_f32_16x16x32_bf16 v[24:27], v[152:155], v[176:179], v[24:27]
  ds_read_b64_tr_b16 v[112:113], v187 offset:512
  ds_read_b64_tr_b16 v[114:115], v187 offset:4608
  v_mfma_f32_16x16x32_bf16 v[28:31], v[156:159], v[176:179], v[28:31]
  v_mfma_f32_16x16x32_bf16 v[32:35], v[160:163], v[176:179], v[32:35]
  s_add_u32 s64, s64, 1
  v_mfma_f32_16x16x32_bf16 v[36:39], v[164:167], v[176:179], v[36:39]
  s_waitcnt vmcnt(20)
  s_barrier
  v_mfma_f32_16x16x32_bf16 v[196:199], v[204:207], v[180:183], v[196:199]
  ds_read_b128 v[172:175], v189 offset:5120
  ds_read_b128 v[176:179], v189 offset:0
  v_mfma_f32_16x16x32_bf16 v[40:43], v[136:139], v[180:183], v[40:43]
  ds_read_b128 v[168:171], v189 offset:1024
  ds_read_b64_tr_b16 v[116:117], v188 offset:512
  v_mfma_f32_16x16x32_bf16 v[44:47], v[140:143], v[180:183], v[44:47]
  s_mov_b32 m0, s67
  v_mfma_f32_16x16x32_bf16 v[48:51], v[144:147], v[180:183], v[48:51]
  buffer_load_dwordx4 v184, s[20:23], s65 offen nt lds
  v_mfma_f32_16x16x32_bf16 v[52:55], v[148:151], v[180:183], v[52:55]
  s_add_u32 m0, s67, 896
  s_add_u32 s67, s67, 8192
  v_mfma_f32_16x16x32_bf16 v[56:59], v[152:155], v[180:183], v[56:59]
  ds_read_b64_tr_b16 v[118:119], v188 offset:4608
  ds_read_b64_tr_b16 v[120:121], v187 offset:1024
  v_mfma_f32_16x16x32_bf16 v[60:63], v[156:159], v[180:183], v[60:63]
  ds_read_b64_tr_b16 v[122:123], v187 offset:5120
  ds_read_b64_tr_b16 v[124:125], v188 offset:1024
  v_mfma_f32_16x16x32_bf16 v[64:67], v[160:163], v[180:183], v[64:67]
  v_mfma_f32_16x16x32_bf16 v[68:71], v[164:167], v[180:183], v[68:71]
  s_waitcnt lgkmcnt(5)
  v_mfma_f32_16x16x32_bf16 v[200:203], v[204:207], v[172:175], v[200:203]
  ds_read_b64_tr_b16 v[126:127], v188 offset:5120
  ds_read_b64_tr_b16 v[128:129], v187 offset:1536
  v_mfma_f32_16x16x32_bf16 v[72:75], v[136:139], v[172:175], v[72:75]
  v_mfma_f32_16x16x32_bf16 v[76:79], v[140:143], v[172:175], v[76:79]
  buffer_load_dwordx4 v184, s[20:23], s65 offen offset:128 nt lds
  v_mfma_f32_16x16x32_bf16 v[80:83], v[144:147], v[172:175], v[80:83]
  s_add_u32 s65, s65, s70
  s_bitset0_b32 s67, 16
  s_mov_b32 m0, s68
  v_mfma_f32_16x16x32_bf16 v[84:87], v[148:151], v[172:175], v[84:87]
  ds_read_b64_tr_b16 v[130:131], v187 offset:5632
  ds_read_b64_tr_b16 v[132:133], v188 offset:1536
  v_mfma_f32_16x16x32_bf16 v[88:91], v[152:155], v[172:175], v[88:91]
  ds_read_b64_tr_b16 v[134:135], v188 offset:5632
  v_mfma_f32_16x16x32_bf16 v[92:95], v[156:159], v[172:175], v[92:95]
  v_mfma_f32_16x16x32_bf16 v[96:99], v[160:163], v[172:175], v[96:99]
  s_cmp_eq_u32 s64, 17
  v_mfma_f32_16x16x32_bf16 v[100:103], v[164:167], v[172:175], v[100:103]
  buffer_load_dwordx4 v185, s[24:27], s66 offen nt lds
  s_cbranch_scc1 L_B_DONEF
  s_waitcnt lgkmcnt(0)
  v_mfma_f32_16x16x32_bf16 v[192:195], v[204:207], v[176:179], v[192:195]
  s_add_u32 m0, s68, 896
  s_add_u32 s68, s68, 8192
  v_mfma_f32_16x16x32_bf16 v[8:11], v[104:107], v[176:179], v[8:11]
  buffer_load_dwordx4 v185, s[24:27], s66 offen offset:128 nt lds
  v_mfma_f32_16x16x32_bf16 v[12:15], v[108:111], v[176:179], v[12:15]
  s_add_u32 s66, s66, s71
  s_bitset1_b32 s68, 16
  s_bitset0_b32 s68, 17
  v_mfma_f32_16x16x32_bf16 v[16:19], v[112:115], v[176:179], v[16:19]
  ds_read_b64_tr_b16 v[136:137], v187 offset:8192
  ds_read_b64_tr_b16 v[138:139], v187 offset:12288
  v_mfma_f32_16x16x32_bf16 v[20:23], v[116:119], v[176:179], v[20:23]
  ds_read_b64_tr_b16 v[140:141], v188 offset:8192
  ds_read_b64_tr_b16 v[142:143], v188 offset:12288
  v_mfma_f32_16x16x32_bf16 v[24:27], v[120:123], v[176:179], v[24:27]
  ds_read_b64_tr_b16 v[144:145], v187 offset:8704
  ds_read_b64_tr_b16 v[146:147], v187 offset:12800
  v_mfma_f32_16x16x32_bf16 v[28:31], v[124:127], v[176:179], v[28:31]
  v_mfma_f32_16x16x32_bf16 v[32:35], v[128:131], v[176:179], v[32:35]
  s_add_u32 s64, s64, 1
  v_mfma_f32_16x16x32_bf16 v[36:39], v[132:135], v[176:179], v[36:39]
  s_cmp_eq_u32 s64, s72
  s_cbranch_scc0 L_B_LOOPF1
  s_branch L_BEVF
  .p2align 6
L_B_LOOPF:
  s_waitcnt vmcnt(20)
  s_barrier
  v_mfma_f32_16x16x32_bf16 v[196:199], v[204:207], v[168:171], v[196:199]
  ds_read_b128 v[172:175], v189 offset:2048
  ds_read_b128 v[176:179], v189 offset:3072
  v_mfma_f32_16x16x32_bf16 v[40:43], v[104:107], v[168:171], v[40:43]
  ds_read_b128 v[180:183], v189 offset:4096
  ds_read_b64_tr_b16 v[148:149], v188 offset:8704
  v_mfma_f32_16x16x32_bf16 v[44:47], v[108:111], v[168:171], v[44:47]
  s_mov_b32 m0, s67
  v_mfma_f32_16x16x32_bf16 v[48:51], v[112:115], v[168:171], v[48:51]
  buffer_load_dwordx4 v184, s[20:23], s65 offen lds
  v_mfma_f32_16x16x32_bf16 v[52:55], v[116:119], v[168:171], v[52:55]
  s_add_u32 m0, s67, 896
  s_add_u32 s67, s67, 8192
  v_mfma_f32_16x16x32_bf16 v[56:59], v[120:123], v[168:171], v[56:59]
  ds_read_b64_tr_b16 v[150:151], v188 offset:12800
  ds_read_b64_tr_b16 v[152:153], v187 offset:9216
  v_mfma_f32_16x16x32_bf16 v[60:63], v[124:127], v[168:171], v[60:63]
  ds_read_b64_tr_b16 v[154:155], v187 offset:13312
  ds_read_b64_tr_b16 v[156:157], v188 offset:9216
  v_mfma_f32_16x16x32_bf16 v[64:67], v[128:131], v[168:171], v[64:67]
  v_mfma_f32_16x16x32_bf16 v[68:71], v[132:135], v[168:171], v[68:71]
  s_waitcnt lgkmcnt(5)
  v_mfma_f32_16x16x32_bf16 v[200:203], v[204:207], v[172:175], v[200:203]
  ds_read_b64_tr_b16 v[158:159], v188 offset:13312
  ds_read_b64_tr_b16 v[160:161], v187 offset:9728
  v_mfma_f32_16x16x32_bf16 v[72:75], v[104:107], v[172:175], v[72:75]
  v_mfma_f32_16x16x32_bf16 v[76:79], v[108:111], v[172:175], v[76:79]
  buffer_load_dwordx4 v184, s[20:23], s65 offen offset:128 lds
  v_mfma_f32_16x16x32_bf16 v[80:83], v[112:115], v[172:175], v[80:83]
  s_add_u32 s65, s65, s70
  s_bitset0_b32 s67, 16
  s_mov_b32 m0, s68
  v_mfma_f32_16x16x32_bf16 v[84:87], v[116:119], v[172:175], v[84:87]
  ds_read_b64_tr_b16 v[162:163], v187 offset:13824
  ds_read_b64_tr_b16 v[164:165], v188 offset:9728
  v_mfma_f32_16x16x32_bf16 v[88:91], v[120:123], v[172:175], v[88:91]
  ds_read_b64_tr_b16 v[166:167], v188 offset:13824
  v_mfma_f32_16x16x32_bf16 v[92:95], v[124:127], v[172:175], v[92:95]
  v_mfma_f32_16x16x32_bf16 v[96:99], v[128:131], v[172:175], v[96:99]
  v_add_u32 v187, 0x4000, v187
  v_and_or_b32 v187, v187, s59, v211
  v_xor_b32 v188, 32, v187
  v_mfma_f32_16x16x32_bf16 v[100:103], v[132:135], v[172:175], v[100:103]
  buffer_load_dwordx4 v185, s[24:27], s66 offen lds
  s_waitcnt lgkmcnt(0)
  v_mfma_f32_16x16x32_bf16 v[192:195], v[204:207], v[176:179], v[192:195]
  s_add_u32 m0, s68, 896
  s_add_u32 s68, s68, 8192
  v_mfma_f32_16x16x32_bf16 v[8:11], v[136:139], v[176:179], v[8:11]
  buffer_load_dwordx4 v185, s[24:27], s66 offen offset:128 lds
  v_mfma_f32_16x16x32_bf16 v[12:15], v[140:143], v[176:179], v[12:15]
  s_add_u32 s66, s66, s71
  s_bitset1_b32 s68, 16
  s_bitset0_b32 s68, 17
  v_mfma_f32_16x16x32_bf16 v[16:19], v[144:147], v[176:179], v[16:19]
  ds_read_b64_tr_b16 v[104:105], v187 offset:0
  ds_read_b64_tr_b16 v[106:107], v187 offset:4096
  v_mfma_f32_16x16x32_bf16 v[20:23], v[148:151], v[176:179], v[20:23]
  ds_read_b64_tr_b16 v[108:109], v188 offset:0
  ds_read_b64_tr_b16 v[110:111], v188 offset:4096
  v_mfma_f32_16x16x32_bf16 v[24:27], v[152:155], v[176:179], v[24:27]
  ds_read_b64_tr_b16 v[112:113], v187 offset:512
  ds_read_b64_tr_b16 v[114:115], v187 offset:4608
  v_mfma_f32_16x16x32_bf16 v[28:31], v[156:159], v[176:179], v[28:31]
  v_mfma_f32_16x16x32_bf16 v[32:35], v[160:163], v[176:179], v[32:35]
  s_add_u32 s64, s64, 1
  v_mfma_f32_16x16x32_bf16 v[36:39], v[164:167], v[176:179], v[36:39]
  s_waitcnt vmcnt(20)
  s_barrier
  v_mfma_f32_16x16x32_bf16 v[196:199], v[204:207], v[180:183], v[196:199]
  ds_read_b128 v[172:175], v189 offset:5120
  ds_read_b128 v[176:179], v189 offset:0
  v_mfma_f32_16x16x32_bf16 v[40:43], v[136:139], v[180:183], v[40:43]
  ds_read_b128 v[168:171], v189 offset:1024
  ds_read_b64_tr_b16 v[116:117], v188 offset:512
  v_mfma_f32_16x16x32_bf16 v[44:47], v[140:143], v[180:183], v[44:47]
  s_mov_b32 m0, s67
  v_mfma_f32_16x16x32_bf16 v[48:51], v[144:147], v[180:183], v[48:51]
  buffer_load_dwordx4 v184, s[20:23], s65 offen lds
  v_mfma_f32_16x16x32_bf16 v[52:55], v[148:151], v[180:183], v[52:55]
  s_add_u32 m0, s67, 896
  s_add_u32 s67, s67, 8192
  v_mfma_f32_16x16x32_bf16 v[56:59], v[152:155], v[180:183], v[56:59]
  ds_read_b64_tr_b16 v[118:119], v188 offset:4608
  ds_read_b64_tr_b16 v[120:121], v187 offset:1024
  v_mfma_f32_16x16x32_bf16 v[60:63], v[156:159], v[180:183], v[60:63]
  ds_read_b64_tr_b16 v[122:123], v187 offset:5120
  ds_read_b64_tr_b16 v[124:125], v188 offset:1024
  v_mfma_f32_16x16x32_bf16 v[64:67], v[160:163], v[180:183], v[64:67]
  v_mfma_f32_16x16x32_bf16 v[68:71], v[164:167], v[180:183], v[68:71]
  s_waitcnt lgkmcnt(5)
  v_mfma_f32_16x16x32_bf16 v[200:203], v[204:207], v[172:175], v[200:203]
  ds_read_b64_tr_b16 v[126:127], v188 offset:5120
  ds_read_b64_tr_b16 v[128:129], v187 offset:1536
  v_mfma_f32_16x16x32_bf16 v[72:75], v[136:139], v[172:175], v[72:75]
  v_mfma_f32_16x16x32_bf16 v[76:79], v[140:143], v[172:175], v[76:79]
  buffer_load_dwordx4 v184, s[20:23], s65 offen offset:128 lds
  v_mfma_f32_16x16x32_bf16 v[80:83], v[144:147], v[172:175], v[80:83]
  s_add_u32 s65, s65, s70
  s_bitset0_b32 s67, 16
  s_mov_b32 m0, s68
  v_mfma_f32_16x16x32_bf16 v[84:87], v[148:151], v[172:175], v[84:87]
  ds_read_b64_tr_b16 v[130:131], v187 offset:5632
  ds_read_b64_tr_b16 v[132:133], v188 offset:1536
  v_mfma_f32_16x16x32_bf16 v[88:91], v[152:155], v[172:175], v[88:91]
  ds_read_b64_tr_b16 v[134:135], v188 offset:5632
  v_mfma_f32_16x16x32_bf16 v[92:95], v[156:159], v[172:175], v[92:95]
  v_mfma_f32_16x16x32_bf16 v[96:99], v[160:163], v[172:175], v[96:99]
  s_cmp_eq_u32 s64, 17
  v_mfma_f32_16x16x32_bf16 v[100:103], v[164:167], v[172:175], v[100:103]
  buffer_load_dwordx4 v185, s[24:27], s66 offen lds
  s_cbranch_scc1 L_B_DONEF
  s_waitcnt lgkmcnt(0)
  v_mfma_f32_16x16x32_bf16 v[192:195], v[204:207], v[176:179], v[192:195]
  s_add_u32 m0, s68, 896
  s_add_u32 s68, s68, 8192
  v_mfma_f32_16x16x32_bf16 v[8:11], v[104:107], v[176:179], v[8:11]
  buffer_load_dwordx4 v185, s[24:27], s66 offen offset:128 lds
  v_mfma_f32_16x16x32_bf16 v[12:15], v[108:111], v[176:179], v[12:15]
  s_add_u32 s66, s66, s71
  s_bitset1_b32 s68, 16
  s_bitset0_b32 s68, 17
  v_mfma_f32_16x16x32_bf16 v[16:19], v[112:115], v[176:179], v[16:19]
  ds_read_b64_tr_b16 v[136:137], v187 offset:8192
  ds_read_b64_tr_b16 v[138:139], v187 offset:12288
  v_mfma_f32_16x16x32_bf16 v[20:23], v[116:119], v[176:179], v[20:23]
  ds_read_b64_tr_b16 v[140:141], v188 offset:8192
  ds_read_b64_tr_b16 v[142:143], v188 offset:12288
  v_mfma_f32_16x16x32_bf16 v[24:27], v[120:123], v[176:179], v[24:27]
  ds_read_b64_tr_b16 v[144:145], v187 offset:8704
  ds_read_b64_tr_b16 v[146:147], v187 offset:12800
  v_mfma_f32_16x16x32_bf16 v[28:31], v[124:127], v[176:179], v[28:31]
  v_mfma_f32_16x16x32_bf16 v[32:35], v[128:131], v[176:179], v[32:35]
  s_add_u32 s64, s64, 1
  v_mfma_f32_16x16x32_bf16 v[36:39], v[132:135], v[176:179], v[36:39]
  s_cmp_eq_u32 s64, s72
  s_cbranch_scc0 L_B_LOOPF
L_BEVF:
  s_cmp_eq_u32 s64, 8
  s_cbranch_scc0 L_BEV2F
  s_mov_b32 s20, s12
  s_and_b32 s21, s13, 0xffff
  s_mov_b32 s22, 0x400000
  s_lshl_b32 s65, s49, 19
  s_lshl_b32 s54, s53, 13
  s_add_u32 s65, s65, s54
  s_lshl_b32 s54, s50, 8
  s_add_u32 s65, s65, s54
  s_mov_b32 s70, 0x8000
  v_mov_b32 v184, v186
  s_mov_b32 s72, 10
  s_branch L_B_LOOPF
L_BEV2F:
  s_cmp_eq_u32 s64, 10
  s_cbranch_scc0 L_BEV3F
  s_mov_b32 s24, s12
  s_and_b32 s25, s13, 0xffff
  s_mov_b32 s26, 0x400000
  s_lshl_b32 s66, s49, 19
  s_lshl_b32 s54, s53, 13
  s_add_u32 s66, s66, s54
  s_lshl_b32 s54, s50, 8
  s_add_u32 s66, s66, s54
  s_add_u32 s66, s66, 0x40000
  s_mov_b32 s71, 0x8000
  v_mov_b32 v185, v186
  s_mov_b32 s72, 16
  s_branch L_B_LOOPF
L_BEV3F:
  s_mov_b32 s22, 0
  s_mov_b32 s67, 0x28000
  s_branch L_B_LOOPF
L_B_DONEF:
  s_add_u32 m0, s68, 896
  s_add_u32 s68, s68, 8192
  buffer_load_dwordx4 v185, s[24:27], s66 offen offset:128 lds
  s_branch L_B_DONE
L_B_DONE:
  s_andn2_b32 s56, s77, 3
  s_add_u32 s56, s56, s53
  s_lshl_b32 s58, s56, 2
  s_add_u32 s58, s58, s50
  s_lshl_b32 s57, s58, 9
  s_add_u32 s57, s57, 0x1200000
  s_mul_i32 s58, s58, 12288
  s_add_u32 s58, s58, 0x600000
  v_lshlrev_b32 v6, 4, v1
  s_mov_b32 s54, 0x71800000
  v_add_f32 v5, v192, v196
  v_add_f32 v5, v5, v200
  v_cmp_nge_f32 vcc, s54, v5
  s_mul_i32 s55, s53, 192
  s_add_u32 s55, s55, 0x27900
  v_lshl_add_u32 v4, v3, 2, s55
  ds_read_b32 v212, v4 offset:0
  ds_read_b32 v213, v4 offset:64
  ds_read_b32 v214, v4 offset:128
  v_mov_b32 v4, 0x27800
  s_cbranch_vccz L_B_GOOD
  v_mov_b32 v5, 1
  ds_write_b32 v4, v5 offset:8
L_B_GOOD:
  v_mov_b32 v222, s74
  v_mov_b32 v223, s75
  v_mov_b32 v7, 0
  s_lshl_b32 s56, s56, 10
  s_lshl_b32 s59, s50, 7
  s_add_u32 s56, s56, s59
  s_add_u32 s56, s56, 0x1600200
  v_lshlrev_b32 v224, 3, v3
  s_waitcnt lgkmcnt(0)
  s_add_u32 s59, s53, 1
  s_and_b32 s59, s59, 3
  s_xor_b32 s59, s59, s50
  s_xor_b32 s54, s62, 15
  s_or_b32 s59, s59, s54
  s_andn2_b32 s54, s77, 3
  s_add_u32 s54, s54, s53
  s_mul_i32 s54, s54, 12288
  s_cmp_eq_u32 s59, 0
  s_cselect_b32 s58, s54, s58
  s_cmp_eq_u32 s53, s50
  s_cbranch_scc1 L_B_PUBL
  s_bitcmp1_b32 s62, s53
  s_cbranch_scc0 L_B_PUBS
  v_cvt_pk_bf16_f32 v104, v8, v9
  v_cvt_pk_bf16_f32 v105, v10, v11
  v_cvt_pk_bf16_f32 v106, v12, v13
  v_cvt_pk_bf16_f32 v107, v14, v15
  buffer_store_dwordx4 v[104:107], v6, s[44:47], s58 offen offset:0
  v_cvt_pk_bf16_f32 v108, v16, v17
  v_cvt_pk_bf16_f32 v109, v18, v19
  v_cvt_pk_bf16_f32 v110, v20, v21
  v_cvt_pk_bf16_f32 v111, v22, v23
  buffer_store_dwordx4 v[108:111], v6, s[44:47], s58 offen offset:1024
  v_cvt_pk_bf16_f32 v112, v24, v25
  v_cvt_pk_bf16_f32 v113, v26, v27
  v_cvt_pk_bf16_f32 v114, v28, v29
  v_cvt_pk_bf16_f32 v115, v30, v31
  buffer_store_dwordx4 v[112:115], v6, s[44:47], s58 offen offset:2048
  v_cvt_pk_bf16_f32 v116, v32, v33
  v_cvt_pk_bf16_f32 v117, v34, v35
  v_cvt_pk_bf16_f32 v118, v36, v37
  v_cvt_pk_bf16_f32 v119, v38, v39
  buffer_store_dwordx4 v[116:119], v6, s[44:47], s58 offen offset:3072
  s_add_u32 s58, s58, 4096
  v_cvt_pk_bf16_f32 v120, v40, v41
  v_cvt_pk_bf16_f32 v121, v42, v43
  v_cvt_pk_bf16_f32 v122, v44, v45
  v_cvt_pk_bf16_f32 v123, v46, v47
  buffer_store_dwordx4 v[120:123], v6, s[44:47], s58 offen offset:0
  v_cvt_pk_bf16_f32 v124, v48, v49
  v_cvt_pk_bf16_f32 v125, v50, v51
  v_cvt_pk_bf16_f32 v126, v52, v53
  v_cvt_pk_bf16_f32 v127, v54, v55
  buffer_store_dwordx4 v[124:127], v6, s[44:47], s58 offen offset:1024
  v_cvt_pk_bf16_f32 v128, v56, v57
  v_cvt_pk_bf16_f32 v129, v58, v59
  v_cvt_pk_bf16_f32 v130, v60, v61
  v_cvt_pk_bf16_f32 v131, v62, v63
  buffer_store_dwordx4 v[128:131], v6, s[44:47], s58 offen offset:2048
  v_cvt_pk_bf16_f32 v132, v64, v65
  v_cvt_pk_bf16_f32 v133, v66, v67
  v_cvt_pk_bf16_f32 v134, v68, v69
  v_cvt_pk_bf16_f32 v135, v70, v71
  buffer_store_dwordx4 v[132:135], v6, s[44:47], s58 offen offset:3072
  s_add_u32 s58, s58, 4096
  v_cvt_pk_bf16_f32 v136, v72, v73
  v_cvt_pk_bf16_f32 v137, v74, v75
  v_cvt_pk_bf16_f32 v138, v76, v77
  v_cvt_pk_bf16_f32 v139, v78, v79
  buffer_store_dwordx4 v[136:139], v6, s[44:47], s58 offen offset:0
  v_cvt_pk_bf16_f32 v140, v80, v81
  v_cvt_pk_bf16_f32 v141, v82, v83
  v_cvt_pk_bf16_f32 v142, v84, v85
  v_cvt_pk_bf16_f32 v143, v86, v87
  buffer_store_dwordx4 v[140:143], v6, s[44:47], s58 offen offset:1024
  v_cvt_pk_bf16_f32 v144, v88, v89
  v_cvt_pk_bf16_f32 v145, v90, v91
  v_cvt_pk_bf16_f32 v146, v92, v93
  v_cvt_pk_bf16_f32 v147, v94, v95
  buffer_store_dwordx4 v[144:147], v6, s[44:47], s58 offen offset:2048
  v_cvt_pk_bf16_f32 v148, v96, v97
  v_cvt_pk_bf16_f32 v149, v98, v99
  v_cvt_pk_bf16_f32 v150, v100, v101
  v_cvt_pk_bf16_f32 v151, v102, v103
  buffer_store_dwordx4 v[148:151], v6, s[44:47], s58 offen offset:3072
  v_sub_f32 v216, 0, v212
  v_mov_b32 v217, v192
  v_sub_f32 v218, 0, v213
  v_mov_b32 v219, v196
  v_sub_f32 v220, 0, v214
  v_mov_b32 v221, v200
  s_mov_b64 exec, 0xffff
  buffer_store_dwordx2 v[216:217], v224, s[44:47], s57 offen offset:0
  buffer_store_dwordx2 v[218:219], v224, s[44:47], s57 offen offset:128
  buffer_store_dwordx2 v[220:221], v224, s[44:47], s57 offen offset:256
  s_mov_b64 exec, -1
  s_barrier
  ds_read_b32 v5, v4 offset:8
  s_waitcnt lgkmcnt(0)
  v_readfirstlane_b32 s54, v5
  s_cmp_lg_u32 s54, 0
  s_cbranch_scc0 L_B_FLAGF
  s_cmp_lg_u32 s73, 0
  s_cbranch_scc0 L_B_SAFE
L_B_FLAGF:
  s_waitcnt vmcnt(0)
  s_mov_b64 exec, 1
  buffer_store_dwordx2 v[222:223], v7, s[44:47], s56 offen
  s_mov_b64 exec, -1
  s_branch L_TAIL
L_B_PUBL:
  v_cvt_pk_bf16_f32 v104, v8, v9
  v_cvt_pk_bf16_f32 v105, v10, v11
  v_cvt_pk_bf16_f32 v106, v12, v13
  v_cvt_pk_bf16_f32 v107, v14, v15
  v_cvt_pk_bf16_f32 v108, v16, v17
  v_cvt_pk_bf16_f32 v109, v18, v19
  v_cvt_pk_bf16_f32 v110, v20, v21
  v_cvt_pk_bf16_f32 v111, v22, v23
  v_cvt_pk_bf16_f32 v112, v24, v25
  v_cvt_pk_bf16_f32 v113, v26, v27
  v_cvt_pk_bf16_f32 v114, v28, v29
  v_cvt_pk_bf16_f32 v115, v30, v31
  v_cvt_pk_bf16_f32 v116, v32, v33
  v_cvt_pk_bf16_f32 v117, v34, v35
  v_cvt_pk_bf16_f32 v118, v36, v37
  v_cvt_pk_bf16_f32 v119, v38, v39
  v_cvt_pk_bf16_f32 v120, v40, v41
  v_cvt_pk_bf16_f32 v121, v42, v43
  v_cvt_pk_bf16_f32 v122, v44, v45
  v_cvt_pk_bf16_f32 v123, v46, v47
  v_cvt_pk_bf16_f32 v124, v48, v49
  v_cvt_pk_bf16_f32 v125, v50, v51
  v_cvt_pk_bf16_f32 v126, v52, v53
  v_cvt_pk_bf16_f32 v127, v54, v55
  v_cvt_pk_bf16_f32 v128, v56, v57
  v_cvt_pk_bf16_f32 v129, v58, v59
  v_cvt_pk_bf16_f32 v130, v60, v61
  v_cvt_pk_bf16_f32 v131, v62, v63
  v_cvt_pk_bf16_f32 v132, v64, v65
  v_cvt_pk_bf16_f32 v133, v66, v67
  v_cvt_pk_bf16_f32 v134, v68, v69
  v_cvt_pk_bf16_f32 v135, v70, v71
  v_cvt_pk_bf16_f32 v136, v72, v73
  v_cvt_pk_bf16_f32 v137, v74, v75
  v_cvt_pk_bf16_f32 v138, v76, v77
  v_cvt_pk_bf16_f32 v139, v78, v79
  v_cvt_pk_bf16_f32 v140, v80, v81
  v_cvt_pk_bf16_f32 v141, v82, v83
  v_cvt_pk_bf16_f32 v142, v84, v85
  v_cvt_pk_bf16_f32 v143, v86, v87
  v_cvt_pk_bf16_f32 v144, v88, v89
  v_cvt_pk_bf16_f32 v145, v90, v91
  v_cvt_pk_bf16_f32 v146, v92, v93
  v_cvt_pk_bf16_f32 v147, v94, v95
  v_cvt_pk_bf16_f32 v148, v96, v97
  v_cvt_pk_bf16_f32 v149, v98, v99
  v_cvt_pk_bf16_f32 v150, v100, v101
  v_cvt_pk_bf16_f32 v151, v102, v103
  v_sub_f32 v216, 0, v212
  v_mov_b32 v217, v192
  v_sub_f32 v218, 0, v213
  v_mov_b32 v219, v196
  v_sub_f32 v220, 0, v214
  v_mov_b32 v221, v200
  v_add_u32 v6, 0x20000, v6
  v_add_u32 v224, 0x20000, v224
  s_barrier
  ds_read_b32 v5, v4 offset:8
  ds_write_b128 v6, v[104:107] offset:0
  ds_write_b128 v6, v[108:111] offset:1024
  ds_write_b128 v6, v[112:115] offset:2048
  ds_write_b128 v6, v[116:119] offset:3072
  ds_write_b128 v6, v[120:123] offset:4096
  ds_write_b128 v6, v[124:127] offset:5120
  ds_write_b128 v6, v[128:131] offset:6144
  ds_write_b128 v6, v[132:135] offset:7168
  ds_write_b128 v6, v[136:139] offset:8192
  ds_write_b128 v6, v[140:143] offset:9216
  ds_write_b128 v6, v[144:147] offset:10240
  ds_write_b128 v6, v[148:151] offset:11264
  ds_write_b64 v224, v[216:217] offset:12288
  ds_write_b64 v224, v[218:219] offset:12416
  ds_write_b64 v224, v[220:221] offset:12544
  s_waitcnt lgkmcnt(0)
  v_readfirstlane_b32 s54, v5
  s_cmp_lg_u32 s54, 0
  s_cbranch_scc0 L_B_FLAGL
  s_cmp_lg_u32 s73, 0
  s_cbranch_scc0 L_B_SAFE
L_B_FLAGL:
  s_waitcnt vmcnt(0)
  s_mov_b64 exec, 1
  buffer_store_dwordx2 v[222:223], v7, s[44:47], s56 offen
  s_mov_b64 exec, -1
L_TAIL:
  s_barrier
  v_lshrrev_b32 v5, 1, v2
  v_and_b32 v6, 1, v2
  v_lshrrev_b32 v4, 2, v3
  v_lshl_add_u32 v4, v6, 2, v4
  v_lshlrev_b32 v4, 6, v4
  v_lshl_add_u32 v4, v5, 11, v4
  v_and_b32 v5, 3, v3
  v_lshl_add_u32 v4, v5, 3, v4
  s_and_b32 s59, s3, 1
  v_xor_b32 v6, s59, v6
  v_lshl_add_u32 v4, v6, 5, v4
  s_lshr_b32 s59, s3, 1
  s_lshl_b32 s59, s59, 9
  v_add_u32 v208, s59, v4
  v_add_u32 v209, 0x10000, v208
  v_lshlrev_b32 v6, 4, v1
  v_mov_b32 v4, 0x27800
  ds_read_b128 v[236:239], v4 offset:32
  ds_read_b64_tr_b16 v[8:9], v208 offset:0
  ds_read_b64_tr_b16 v[10:11], v208 offset:4096
  ds_read_b64_tr_b16 v[12:13], v208 offset:8192
  ds_read_b64_tr_b16 v[14:15], v208 offset:12288
  ds_read_b64_tr_b16 v[16:17], v208 offset:16384
  ds_read_b64_tr_b16 v[18:19], v208 offset:20480
  ds_read_b64_tr_b16 v[20:21], v208 offset:24576
  ds_read_b64_tr_b16 v[22:23], v208 offset:28672
  ds_read_b64_tr_b16 v[24:25], v208 offset:32768
  ds_read_b64_tr_b16 v[26:27], v208 offset:36864
  ds_read_b64_tr_b16 v[28:29], v208 offset:40960
  ds_read_b64_tr_b16 v[30:31], v208 offset:45056
  ds_read_b64_tr_b16 v[32:33], v208 offset:49152
  ds_read_b64_tr_b16 v[34:35], v208 offset:53248
  ds_read_b64_tr_b16 v[36:37], v208 offset:57344
  ds_read_b64_tr_b16 v[38:39], v208 offset:61440
  ds_read_b64_tr_b16 v[40:41], v209 offset:0
  ds_read_b64_tr_b16 v[42:43], v209 offset:4096
  ds_read_b64_tr_b16 v[44:45], v209 offset:8192
  ds_read_b64_tr_b16 v[46:47], v209 offset:12288
  ds_read_b64_tr_b16 v[48:49], v209 offset:16384
  ds_read_b64_tr_b16 v[50:51], v209 offset:20480
  ds_read_b64_tr_b16 v[52:53], v209 offset:24576
  ds_read_b64_tr_b16 v[54:55], v209 offset:28672
  ds_read_b64_tr_b16 v[56:57], v209 offset:32768
  ds_read_b64_tr_b16 v[58:59], v209 offset:36864
  ds_read_b64_tr_b16 v[60:61], v209 offset:40960
  ds_read_b64_tr_b16 v[62:63], v209 offset:45056
  ds_read_b64_tr_b16 v[64:65], v209 offset:49152
  ds_read_b64_tr_b16 v[66:67], v209 offset:53248
  ds_read_b64_tr_b16 v[68:69], v209 offset:57344
  ds_read_b64_tr_b16 v[70:71], v209 offset:61440
  s_cmp_ge_u32 s3, 6
  s_cbranch_scc1 L_T_NOCOMB0
  s_lshl_b32 s58, s77, 10
  s_add_u32 s58, s58, 0x1600000
  v_lshlrev_b32 v4, 7, v1
  s_mov_b64 exec, 0xf
  s_mov_b32 s69, 0
L_T_POLL2:
  buffer_load_dwordx2 v[200:201], v4, s[44:47], s58 offen offset:512 sc1
  s_add_u32 s69, s69, 1
  s_waitcnt vmcnt(0)
  v_cmp_ne_u64 vcc, s[74:75], v[200:201]
  s_cmp_ge_u32 s69, 100000
  s_cbranch_scc1 L_T_POLL2_OUT
  s_cbranch_vccz L_T_POLL2_OUT
  s_mov_b64 exec, vcc
  s_sleep 1
  s_branch L_T_POLL2
L_T_POLL2_OUT:
  s_mov_b64 exec, -1
  s_waitcnt lgkmcnt(15)
  v_and_b32 v5, v236, v237
  v_and_b32 v7, v238, v239
  v_and_b32 v5, v5, v7
  s_nop 0
  v_readfirstlane_b32 s57, v5
  s_lshl_b32 s59, s77, 2
  s_lshl_b32 s54, s59, 9
  s_add_u32 s54, s54, 0x1200000
  s_lshr_b32 s55, s3, 1
  s_lshl_b32 s55, s55, 7
  s_add_u32 s54, s54, s55
  v_lshlrev_b32 v4, 3, v3
  s_add_u32 s56, s55, 0x23000
  v_add_u32 v5, s56, v4
  ds_read_b64 v[200:201], v5
  s_add_u32 s56, s50, 1
  s_and_b32 s56, s56, 3
  s_lshl_b32 s56, s56, 9
  s_add_u32 s56, s56, s54
  buffer_load_dwordx2 v[202:203], v4, s[44:47], s56 offen sc1
  s_add_u32 s56, s50, 2
  s_and_b32 s56, s56, 3
  s_lshl_b32 s56, s56, 9
  s_add_u32 s56, s56, s54
  buffer_load_dwordx2 v[204:205], v4, s[44:47], s56 offen sc1
  s_add_u32 s56, s50, 3
  s_and_b32 s56, s56, 3
  s_lshl_b32 s56, s56, 9
  s_add_u32 s56, s56, s54
  buffer_load_dwordx2 v[206:207], v4, s[44:47], s56 offen sc1
  s_mul_i32 s59, s59, 12288
  s_add_u32 s59, s59, 0x600000
  s_lshl_b32 s55, s3, 11
  s_add_u32 s59, s59, s55
  s_add_u32 s56, s50, 1
  s_and_b32 s56, s56, 3
  s_mul_i32 s56, s56, 12288
  s_add_u32 s56, s56, s59
  s_mul_i32 s54, s77, 12288
  s_add_u32 s54, s54, s55
  s_cmp_lg_u32 s57, 0
  s_cselect_b32 s56, s54, s56
  buffer_load_dwordx4 v[172:175], v6, s[44:47], s56 offen offset:0 sc1
  buffer_load_dwordx4 v[188:191], v6, s[44:47], s56 offen offset:1024 sc1
  s_add_u32 s56, s50, 2
  s_and_b32 s56, s56, 3
  s_mul_i32 s56, s56, 12288
  s_add_u32 s56, s56, s59
  buffer_load_dwordx4 v[176:179], v6, s[44:47], s56 offen offset:0 sc1
  buffer_load_dwordx4 v[192:195], v6, s[44:47], s56 offen offset:1024 sc1
  s_add_u32 s56, s50, 3
  s_and_b32 s56, s56, 3
  s_mul_i32 s56, s56, 12288
  s_add_u32 s56, s56, s59
  buffer_load_dwordx4 v[180:183], v6, s[44:47], s56 offen offset:0 sc1
  buffer_load_dwordx4 v[196:199], v6, s[44:47], s56 offen offset:1024 sc1
  s_add_u32 s56, s55, 0x20000
  v_add_u32 v5, s56, v6
  ds_read_b128 v[168:171], v5 offset:0
  ds_read_b128 v[184:187], v5 offset:1024
  s_waitcnt lgkmcnt(0)
  s_barrier
  v_and_b32 v236, v236, v237
  v_and_b32 v238, v238, v239
  v_and_b32 v236, v236, v238
  s_mul_i32 s59, s77, 12288
  s_add_u32 s59, s59, s55
  v_readfirstlane_b32 s56, v236
  s_waitcnt vmcnt(6)
  v_max_f32 v210, v200, v202
  v_max3_f32 v210, v210, v204, v206
  v_sub_f32 v212, v200, v210
  v_sub_f32 v214, v202, v210
  v_sub_f32 v216, v204, v210
  v_sub_f32 v218, v206, v210
  v_exp_f32 v212, v212
  v_exp_f32 v214, v214
  v_exp_f32 v216, v216
  v_exp_f32 v218, v218
  s_nop 0
  v_mul_f32 v211, v212, v201
  v_fmac_f32 v211, v214, v203
  v_fmac_f32 v211, v216, v205
  v_fmac_f32 v211, v218, v207
  v_rcp_f32 v211, v211
  s_nop 0
  v_mul_f32 v212, v212, v211
  v_mov_b32 v213, v212
  v_mul_f32 v214, v214, v211
  v_mov_b32 v215, v214
  v_mul_f32 v216, v216, v211
  v_mov_b32 v217, v216
  v_mul_f32 v218, v218, v211
  v_mov_b32 v219, v218
  s_waitcnt vmcnt(6)
  v_lshlrev_b32 v236, 16, v168
  v_and_b32 v237, 0xffff0000, v168
  v_pk_mul_f32 v[220:221], v[236:237], v[212:213]
  v_lshlrev_b32 v238, 16, v169
  v_and_b32 v239, 0xffff0000, v169
  v_pk_mul_f32 v[222:223], v[238:239], v[212:213]
  v_lshlrev_b32 v236, 16, v170
  v_and_b32 v237, 0xffff0000, v170
  v_pk_mul_f32 v[224:225], v[236:237], v[212:213]
  v_lshlrev_b32 v238, 16, v171
  v_and_b32 v239, 0xffff0000, v171
  v_pk_mul_f32 v[226:227], v[238:239], v[212:213]
  v_lshlrev_b32 v236, 16, v184
  v_and_b32 v237, 0xffff0000, v184
  v_pk_mul_f32 v[228:229], v[236:237], v[212:213]
  v_lshlrev_b32 v238, 16, v185
  v_and_b32 v239, 0xffff0000, v185
  v_pk_mul_f32 v[230:231], v[238:239], v[212:213]
  v_lshlrev_b32 v236, 16, v186
  v_and_b32 v237, 0xffff0000, v186
  v_pk_mul_f32 v[232:233], v[236:237], v[212:213]
  v_lshlrev_b32 v238, 16, v187
  v_and_b32 v239, 0xffff0000, v187
  v_pk_mul_f32 v[234:235], v[238:239], v[212:213]
  s_waitcnt vmcnt(4)
  v_lshlrev_b32 v236, 16, v172
  v_and_b32 v237, 0xffff0000, v172
  v_pk_fma_f32 v[220:221], v[236:237], v[214:215], v[220:221]
  v_lshlrev_b32 v238, 16, v173
  v_and_b32 v239, 0xffff0000, v173
  v_pk_fma_f32 v[222:223], v[238:239], v[214:215], v[222:223]
  v_lshlrev_b32 v236, 16, v174
  v_and_b32 v237, 0xffff0000, v174
  v_pk_fma_f32 v[224:225], v[236:237], v[214:215], v[224:225]
  v_lshlrev_b32 v238, 16, v175
  v_and_b32 v239, 0xffff0000, v175
  v_pk_fma_f32 v[226:227], v[238:239], v[214:215], v[226:227]
  v_lshlrev_b32 v236, 16, v188
  v_and_b32 v237, 0xffff0000, v188
  v_pk_fma_f32 v[228:229], v[236:237], v[214:215], v[228:229]
  v_lshlrev_b32 v238, 16, v189
  v_and_b32 v239, 0xffff0000, v189
  v_pk_fma_f32 v[230:231], v[238:239], v[214:215], v[230:231]
  v_lshlrev_b32 v236, 16, v190
  v_and_b32 v237, 0xffff0000, v190
  v_pk_fma_f32 v[232:233], v[236:237], v[214:215], v[232:233]
  v_lshlrev_b32 v238, 16, v191
  v_and_b32 v239, 0xffff0000, v191
  v_pk_fma_f32 v[234:235], v[238:239], v[214:215], v[234:235]
  s_waitcnt vmcnt(2)
  v_lshlrev_b32 v236, 16, v176
  v_and_b32 v237, 0xffff0000, v176
  v_pk_fma_f32 v[220:221], v[236:237], v[216:217], v[220:221]
  v_lshlrev_b32 v238, 16, v177
  v_and_b32 v239, 0xffff0000, v177
  v_pk_fma_f32 v[222:223], v[238:239], v[216:217], v[222:223]
  v_lshlrev_b32 v236, 16, v178
  v_and_b32 v237, 0xffff0000, v178
  v_pk_fma_f32 v[224:225], v[236:237], v[216:217], v[224:225]
  v_lshlrev_b32 v238, 16, v179
  v_and_b32 v239, 0xffff0000, v179
  v_pk_fma_f32 v[226:227], v[238:239], v[216:217], v[226:227]
  v_lshlrev_b32 v236, 16, v192
  v_and_b32 v237, 0xffff0000, v192
  v_pk_fma_f32 v[228:229], v[236:237], v[216:217], v[228:229]
  v_lshlrev_b32 v238, 16, v193
  v_and_b32 v239, 0xffff0000, v193
  v_pk_fma_f32 v[230:231], v[238:239], v[216:217], v[230:231]
  v_lshlrev_b32 v236, 16, v194
  v_and_b32 v237, 0xffff0000, v194
  v_pk_fma_f32 v[232:233], v[236:237], v[216:217], v[232:233]
  v_lshlrev_b32 v238, 16, v195
  v_and_b32 v239, 0xffff0000, v195
  v_pk_fma_f32 v[234:235], v[238:239], v[216:217], v[234:235]
  s_waitcnt vmcnt(0)
  v_lshlrev_b32 v236, 16, v180
  v_and_b32 v237, 0xffff0000, v180
  v_pk_fma_f32 v[220:221], v[236:237], v[218:219], v[220:221]
  v_lshlrev_b32 v238, 16, v181
  v_and_b32 v239, 0xffff0000, v181
  v_pk_fma_f32 v[222:223], v[238:239], v[218:219], v[222:223]
  v_lshlrev_b32 v236, 16, v182
  v_and_b32 v237, 0xffff0000, v182
  v_pk_fma_f32 v[224:225], v[236:237], v[218:219], v[224:225]
  v_lshlrev_b32 v238, 16, v183
  v_and_b32 v239, 0xffff0000, v183
  v_pk_fma_f32 v[226:227], v[238:239], v[218:219], v[226:227]
  v_lshlrev_b32 v236, 16, v196
  v_and_b32 v237, 0xffff0000, v196
  v_pk_fma_f32 v[228:229], v[236:237], v[218:219], v[228:229]
  v_lshlrev_b32 v238, 16, v197
  v_and_b32 v239, 0xffff0000, v197
  v_pk_fma_f32 v[230:231], v[238:239], v[218:219], v[230:231]
  v_lshlrev_b32 v236, 16, v198
  v_and_b32 v237, 0xffff0000, v198
  v_pk_fma_f32 v[232:233], v[236:237], v[218:219], v[232:233]
  v_lshlrev_b32 v238, 16, v199
  v_and_b32 v239, 0xffff0000, v199
  v_pk_fma_f32 v[234:235], v[238:239], v[218:219], v[234:235]
  v_cvt_pk_bf16_f32 v168, v220, v221
  v_cvt_pk_bf16_f32 v169, v222, v223
  v_cvt_pk_bf16_f32 v170, v224, v225
  v_cvt_pk_bf16_f32 v171, v226, v227
  v_cvt_pk_bf16_f32 v172, v228, v229
  v_cvt_pk_bf16_f32 v173, v230, v231
  v_cvt_pk_bf16_f32 v174, v232, v233
  v_cvt_pk_bf16_f32 v175, v234, v235
  v_mov_b32 v4, 0x27800
  v_mov_b32 v5, 1
  v_mov_b32 v7, 0
  v_mov_b32 v200, s74
  v_mov_b32 v201, s75
  s_cmp_eq_u32 s56, 0
  s_cbranch_scc1 L_T_OPUBS
  buffer_store_dwordx4 v[168:171], v6, s[44:47], s59 offen
  buffer_store_dwordx4 v[172:175], v6, s[44:47], s59 offen offset:1024
  s_waitcnt vmcnt(0)
  s_mov_b64 exec, 1
  ds_add_rtn_u32 v236, v4, v5 offset:24
  s_waitcnt lgkmcnt(0)
  v_readfirstlane_b32 s54, v236
  s_cmp_lg_u32 s54, 5
  s_cbranch_scc1 L_T_ONOFF
  buffer_store_dwordx2 v[200:201], v7, s[44:47], s58 offen offset:256
L_T_ONOFF:
  s_mov_b64 exec, -1
  s_branch L_T_NOCOMB
L_T_NOCOMB0:
  s_waitcnt lgkmcnt(0)
  s_barrier
L_T_NOCOMB:
  s_andn2_b32 s57, s77, 3
  s_lshr_b32 s55, s3, 1
  s_add_u32 s57, s57, s55
  s_lshl_b32 s58, s57, 10
  s_add_u32 s58, s58, 0x1600000
  v_mov_b32 v7, 0
  s_mov_b64 exec, 0x1
  s_mov_b32 s69, 0
L_T_POLLO:
  buffer_load_dwordx2 v[200:201], v7, s[44:47], s58 offen offset:256 sc1
  s_add_u32 s69, s69, 1
  s_waitcnt vmcnt(0)
  v_cmp_ne_u64 vcc, s[74:75], v[200:201]
  s_cmp_ge_u32 s69, 100000
  s_cbranch_scc1 L_T_POLLO_OUT
  s_cbranch_vccz L_T_POLLO_OUT
  s_mov_b64 exec, vcc
  s_sleep 1
  s_branch L_T_POLLO
L_T_POLLO_OUT:
  s_mov_b64 exec, -1
  s_mul_i32 s59, s57, 12288
  s_and_b32 s54, s3, 1
  s_mul_i32 s54, s54, 6144
  s_add_u32 s59, s59, s54
  s_mul_i32 s54, s3, 6144
  s_mov_b32 m0, s54
  s_nop 0
  buffer_load_dwordx4 v6, s[44:47], s59 offen offset:0 sc1 lds
  buffer_load_dwordx4 v6, s[44:47], s59 offen offset:1024 sc1 lds
  buffer_load_dwordx4 v6, s[44:47], s59 offen offset:2048 sc1 lds
  buffer_load_dwordx4 v6, s[44:47], s59 offen offset:3072 sc1 lds
  s_add_u32 m0, s54, 4096
  s_add_u32 s59, s59, 4096
  buffer_load_dwordx4 v6, s[44:47], s59 offen offset:0 sc1 lds
  buffer_load_dwordx4 v6, s[44:47], s59 offen offset:1024 sc1 lds
  s_lshl_b32 s57, s48, 5
  s_lshl_b32 s54, s3, 2
  s_add_u32 s57, s57, s54
  s_add_u32 s57, s57, s50
  s_lshl_b32 s59, s57, 3
  s_add_u32 s59, s59, s49
  s_mul_i32 s59, s59, 1536
  s_add_u32 s59, s59, 0x1280000
  s_lshl_b32 s58, s57, 10
  s_lshl_b32 s54, s49, 3
  s_add_u32 s58, s58, s54
  s_add_u32 s58, s58, 0x1600180
  v_lshlrev_b32 v4, 3, v1
  v_mov_b32 v200, s74
  v_mov_b32 v201, s75
  s_waitcnt vmcnt(0)
  s_barrier
  ds_read_b128 v[72:75], v6 offset:0
  ds_read_b128 v[76:79], v6 offset:4096
  ds_read_b128 v[80:83], v6 offset:8192
  ds_read_b128 v[84:87], v6 offset:1024
  ds_read_b128 v[88:91], v6 offset:5120
  ds_read_b128 v[92:95], v6 offset:9216
  ds_read_b128 v[96:99], v6 offset:2048
  ds_read_b128 v[100:103], v6 offset:6144
  s_waitcnt lgkmcnt(7)
  v_mfma_f32_16x16x32_bf16 v[120:123], v[8:11], v[72:75], 0
  ds_read_b128 v[104:107], v6 offset:10240
  s_waitcnt lgkmcnt(7)
  v_mfma_f32_16x16x32_bf16 v[124:127], v[8:11], v[76:79], 0
  ds_read_b128 v[108:111], v6 offset:3072
  s_waitcnt lgkmcnt(7)
  v_mfma_f32_16x16x32_bf16 v[128:131], v[8:11], v[80:83], 0
  ds_read_b128 v[112:115], v6 offset:7168
  s_waitcnt lgkmcnt(7)
  v_mfma_f32_16x16x32_bf16 v[120:123], v[12:15], v[84:87], v[120:123]
  ds_read_b128 v[116:119], v6 offset:11264
  s_waitcnt lgkmcnt(7)
  v_mfma_f32_16x16x32_bf16 v[124:127], v[12:15], v[88:91], v[124:127]
  ds_read_b128 v[72:75], v6 offset:12288
  s_waitcnt lgkmcnt(7)
  v_mfma_f32_16x16x32_bf16 v[128:131], v[12:15], v[92:95], v[128:131]
  ds_read_b128 v[76:79], v6 offset:16384
  s_waitcnt lgkmcnt(7)
  v_mfma_f32_16x16x32_bf16 v[120:123], v[16:19], v[96:99], v[120:123]
  ds_read_b128 v[80:83], v6 offset:20480
  s_waitcnt lgkmcnt(7)
  v_mfma_f32_16x16x32_bf16 v[124:127], v[16:19], v[100:103], v[124:127]
  ds_read_b128 v[84:87], v6 offset:13312
  s_waitcnt lgkmcnt(7)
  v_mfma_f32_16x16x32_bf16 v[128:131], v[16:19], v[104:107], v[128:131]
  ds_read_b128 v[88:91], v6 offset:17408
  s_waitcnt lgkmcnt(7)
  v_mfma_f32_16x16x32_bf16 v[120:123], v[20:23], v[108:111], v[120:123]
  ds_read_b128 v[92:95], v6 offset:21504
  s_waitcnt lgkmcnt(7)
  v_mfma_f32_16x16x32_bf16 v[124:127], v[20:23], v[112:115], v[124:127]
  ds_read_b128 v[96:99], v6 offset:14336
  s_waitcnt lgkmcnt(7)
  v_mfma_f32_16x16x32_bf16 v[128:131], v[20:23], v[116:119], v[128:131]
  ds_read_b128 v[100:103], v6 offset:18432
  s_waitcnt lgkmcnt(7)
  v_mfma_f32_16x16x32_bf16 v[120:123], v[24:27], v[72:75], v[120:123]
  ds_read_b128 v[104:107], v6 offset:22528
  s_waitcnt lgkmcnt(7)
  v_mfma_f32_16x16x32_bf16 v[124:127], v[24:27], v[76:79], v[124:127]
  ds_read_b128 v[108:111], v6 offset:15360
  s_waitcnt lgkmcnt(7)
  v_mfma_f32_16x16x32_bf16 v[128:131], v[24:27], v[80:83], v[128:131]
  ds_read_b128 v[112:115], v6 offset:19456
  s_waitcnt lgkmcnt(7)
  v_mfma_f32_16x16x32_bf16 v[120:123], v[28:31], v[84:87], v[120:123]
  ds_read_b128 v[116:119], v6 offset:23552
  s_waitcnt lgkmcnt(7)
  v_mfma_f32_16x16x32_bf16 v[124:127], v[28:31], v[88:91], v[124:127]
  ds_read_b128 v[72:75], v6 offset:24576
  s_waitcnt lgkmcnt(7)
  v_mfma_f32_16x16x32_bf16 v[128:131], v[28:31], v[92:95], v[128:131]
  ds_read_b128 v[76:79], v6 offset:28672
  s_waitcnt lgkmcnt(7)
  v_mfma_f32_16x16x32_bf16 v[120:123], v[32:35], v[96:99], v[120:123]
  ds_read_b128 v[80:83], v6 offset:32768
  s_waitcnt lgkmcnt(7)
  v_mfma_f32_16x16x32_bf16 v[124:127], v[32:35], v[100:103], v[124:127]
  ds_read_b128 v[84:87], v6 offset:25600
  s_waitcnt lgkmcnt(7)
  v_mfma_f32_16x16x32_bf16 v[128:131], v[32:35], v[104:107], v[128:131]
  ds_read_b128 v[88:91], v6 offset:29696
  s_waitcnt lgkmcnt(7)
  v_mfma_f32_16x16x32_bf16 v[120:123], v[36:39], v[108:111], v[120:123]
  ds_read_b128 v[92:95], v6 offset:33792
  s_waitcnt lgkmcnt(7)
  v_mfma_f32_16x16x32_bf16 v[124:127], v[36:39], v[112:115], v[124:127]
  ds_read_b128 v[96:99], v6 offset:26624
  s_waitcnt lgkmcnt(7)
  v_mfma_f32_16x16x32_bf16 v[128:131], v[36:39], v[116:119], v[128:131]
  ds_read_b128 v[100:103], v6 offset:30720
  s_waitcnt lgkmcnt(7)
  v_mfma_f32_16x16x32_bf16 v[120:123], v[40:43], v[72:75], v[120:123]
  ds_read_b128 v[104:107], v6 offset:34816
  s_waitcnt lgkmcnt(7)
  v_mfma_f32_16x16x32_bf16 v[124:127], v[40:43], v[76:79], v[124:127]
  ds_read_b128 v[108:111], v6 offset:27648
  s_waitcnt lgkmcnt(7)
  v_mfma_f32_16x16x32_bf16 v[128:131], v[40:43], v[80:83], v[128:131]
  ds_read_b128 v[112:115], v6 offset:31744
  s_waitcnt lgkmcnt(7)
  v_mfma_f32_16x16x32_bf16 v[120:123], v[44:47], v[84:87], v[120:123]
  ds_read_b128 v[116:119], v6 offset:35840
  s_waitcnt lgkmcnt(7)
  v_mfma_f32_16x16x32_bf16 v[124:127], v[44:47], v[88:91], v[124:127]
  ds_read_b128 v[72:75], v6 offset:36864
  s_waitcnt lgkmcnt(7)
  v_mfma_f32_16x16x32_bf16 v[128:131], v[44:47], v[92:95], v[128:131]
  ds_read_b128 v[76:79], v6 offset:40960
  s_waitcnt lgkmcnt(7)
  v_mfma_f32_16x16x32_bf16 v[120:123], v[48:51], v[96:99], v[120:123]
  ds_read_b128 v[80:83], v6 offset:45056
  s_waitcnt lgkmcnt(7)
  v_mfma_f32_16x16x32_bf16 v[124:127], v[48:51], v[100:103], v[124:127]
  ds_read_b128 v[84:87], v6 offset:37888
  s_waitcnt lgkmcnt(7)
  v_mfma_f32_16x16x32_bf16 v[128:131], v[48:51], v[104:107], v[128:131]
  ds_read_b128 v[88:91], v6 offset:41984
  s_waitcnt lgkmcnt(7)
  v_mfma_f32_16x16x32_bf16 v[120:123], v[52:55], v[108:111], v[120:123]
  ds_read_b128 v[92:95], v6 offset:46080
  s_waitcnt lgkmcnt(7)
  v_mfma_f32_16x16x32_bf16 v[124:127], v[52:55], v[112:115], v[124:127]
  ds_read_b128 v[96:99], v6 offset:38912
  s_waitcnt lgkmcnt(7)
  v_mfma_f32_16x16x32_bf16 v[128:131], v[52:55], v[116:119], v[128:131]
  ds_read_b128 v[100:103], v6 offset:43008
  s_waitcnt lgkmcnt(7)
  v_mfma_f32_16x16x32_bf16 v[120:123], v[56:59], v[72:75], v[120:123]
  ds_read_b128 v[104:107], v6 offset:47104
  s_waitcnt lgkmcnt(7)
  v_mfma_f32_16x16x32_bf16 v[124:127], v[56:59], v[76:79], v[124:127]
  ds_read_b128 v[108:111], v6 offset:39936
  s_waitcnt lgkmcnt(7)
  v_mfma_f32_16x16x32_bf16 v[128:131], v[56:59], v[80:83], v[128:131]
  ds_read_b128 v[112:115], v6 offset:44032
  s_waitcnt lgkmcnt(7)
  v_mfma_f32_16x16x32_bf16 v[120:123], v[60:63], v[84:87], v[120:123]
  ds_read_b128 v[116:119], v6 offset:48128
  s_waitcnt lgkmcnt(7)
  v_mfma_f32_16x16x32_bf16 v[124:127], v[60:63], v[88:91], v[124:127]
  s_waitcnt lgkmcnt(6)
  v_mfma_f32_16x16x32_bf16 v[128:131], v[60:63], v[92:95], v[128:131]
  s_waitcnt lgkmcnt(5)
  v_mfma_f32_16x16x32_bf16 v[120:123], v[64:67], v[96:99], v[120:123]
  s_waitcnt lgkmcnt(4)
  v_mfma_f32_16x16x32_bf16 v[124:127], v[64:67], v[100:103], v[124:127]
  s_waitcnt lgkmcnt(3)
  v_mfma_f32_16x16x32_bf16 v[128:131], v[64:67], v[104:107], v[128:131]
  s_waitcnt lgkmcnt(2)
  v_mfma_f32_16x16x32_bf16 v[120:123], v[68:71], v[108:111], v[120:123]
  s_waitcnt lgkmcnt(1)
  v_mfma_f32_16x16x32_bf16 v[124:127], v[68:71], v[112:115], v[124:127]
  s_waitcnt lgkmcnt(0)
  v_mfma_f32_16x16x32_bf16 v[128:131], v[68:71], v[116:119], v[128:131]
  s_nop 7
  v_cvt_pk_bf16_f32 v168, v120, v121
  v_cvt_pk_bf16_f32 v169, v122, v123
  buffer_store_dwordx2 v[168:169], v4, s[44:47], s59 offen offset:0 sc1
  v_cvt_pk_bf16_f32 v170, v124, v125
  v_cvt_pk_bf16_f32 v171, v126, v127
  buffer_store_dwordx2 v[170:171], v4, s[44:47], s59 offen offset:512 sc1
  v_cvt_pk_bf16_f32 v172, v128, v129
  v_cvt_pk_bf16_f32 v173, v130, v131
  buffer_store_dwordx2 v[172:173], v4, s[44:47], s59 offen offset:1024 sc1
  s_waitcnt vmcnt(0)
  s_mov_b64 exec, 1
  buffer_store_dwordx2 v[200:201], v7, s[44:47], s58 offen sc1
  s_mov_b64 exec, -1
  s_cmp_ge_u32 s3, 3
  s_cbranch_scc1 L_FIN
  s_lshl_b32 s58, s77, 10
  s_add_u32 s58, s58, 0x1600000
  s_mov_b64 exec, 0xff
  s_mov_b32 s69, 0
L_T_POLL3:
  buffer_load_dwordx2 v[202:203], v4, s[44:47], s58 offen offset:384 sc1
  s_add_u32 s69, s69, 1
  s_waitcnt vmcnt(0)
  v_cmp_ne_u64 vcc, s[74:75], v[202:203]
  s_cmp_ge_u32 s69, 100000
  s_cbranch_scc1 L_T_POLL3_OUT
  s_cbranch_vccz L_T_POLL3_OUT
  s_mov_b64 exec, vcc
  s_sleep 1
  s_branch L_T_POLL3
L_T_POLL3_OUT:
  s_mov_b64 exec, -1
  s_mul_i32 s59, s77, 12288
  s_lshl_b32 s55, s3, 9
  s_add_u32 s59, s59, s55
  s_add_u32 s59, s59, 0x1280000
  buffer_load_dwordx2 v[168:169], v4, s[44:47], s59 offen offset:0 sc1
  buffer_load_dwordx2 v[170:171], v4, s[44:47], s59 offen offset:1536 sc1
  s_add_u32 s59, s59, 3072
  buffer_load_dwordx2 v[172:173], v4, s[44:47], s59 offen offset:0 sc1
  buffer_load_dwordx2 v[174:175], v4, s[44:47], s59 offen offset:1536 sc1
  s_add_u32 s59, s59, 3072
  buffer_load_dwordx2 v[176:177], v4, s[44:47], s59 offen offset:0 sc1
  buffer_load_dwordx2 v[178:179], v4, s[44:47], s59 offen offset:1536 sc1
  s_add_u32 s59, s59, 3072
  buffer_load_dwordx2 v[180:181], v4, s[44:47], s59 offen offset:0 sc1
  buffer_load_dwordx2 v[182:183], v4, s[44:47], s59 offen offset:1536 sc1
  s_add_u32 s59, s59, 3072
  s_mul_i32 s59, s48, 48
  s_lshl_b32 s55, s3, 4
  s_add_u32 s59, s59, s55
  s_lshl_b32 s59, s59, 10
  s_lshl_b32 s55, s50, 8
  s_add_u32 s59, s59, s55
  s_lshl_b32 s55, s49, 5
  s_add_u32 s59, s59, s55
  v_lshlrev_b32 v5, 3, v2
  v_lshl_add_u32 v5, v3, 10, v5
  s_waitcnt vmcnt(7)
  v_lshlrev_b32 v220, 16, v168
  v_and_b32 v221, 0xffff0000, v168
  v_lshlrev_b32 v222, 16, v169
  v_and_b32 v223, 0xffff0000, v169
  s_waitcnt vmcnt(6)
  v_lshlrev_b32 v236, 16, v170
  v_and_b32 v237, 0xffff0000, v170
  v_pk_add_f32 v[220:221], v[220:221], v[236:237]
  v_lshlrev_b32 v238, 16, v171
  v_and_b32 v239, 0xffff0000, v171
  v_pk_add_f32 v[222:223], v[222:223], v[238:239]
  s_waitcnt vmcnt(5)
  v_lshlrev_b32 v236, 16, v172
  v_and_b32 v237, 0xffff0000, v172
  v_pk_add_f32 v[220:221], v[220:221], v[236:237]
  v_lshlrev_b32 v238, 16, v173
  v_and_b32 v239, 0xffff0000, v173
  v_pk_add_f32 v[222:223], v[222:223], v[238:239]
  s_waitcnt vmcnt(4)
  v_lshlrev_b32 v236, 16, v174
  v_and_b32 v237, 0xffff0000, v174
  v_pk_add_f32 v[220:221], v[220:221], v[236:237]
  v_lshlrev_b32 v238, 16, v175
  v_and_b32 v239, 0xffff0000, v175
  v_pk_add_f32 v[222:223], v[222:223], v[238:239]
  s_waitcnt vmcnt(3)
  v_lshlrev_b32 v236, 16, v176
  v_and_b32 v237, 0xffff0000, v176
  v_pk_add_f32 v[220:221], v[220:221], v[236:237]
  v_lshlrev_b32 v238, 16, v177
  v_and_b32 v239, 0xffff0000, v177
  v_pk_add_f32 v[222:223], v[222:223], v[238:239]
  s_waitcnt vmcnt(2)
  v_lshlrev_b32 v236, 16, v178
  v_and_b32 v237, 0xffff0000, v178
  v_pk_add_f32 v[220:221], v[220:221], v[236:237]
  v_lshlrev_b32 v238, 16, v179
  v_and_b32 v239, 0xffff0000, v179
  v_pk_add_f32 v[222:223], v[222:223], v[238:239]
  s_waitcnt vmcnt(1)
  v_lshlrev_b32 v236, 16, v180
  v_and_b32 v237, 0xffff0000, v180
  v_pk_add_f32 v[220:221], v[220:221], v[236:237]
  v_lshlrev_b32 v238, 16, v181
  v_and_b32 v239, 0xffff0000, v181
  v_pk_add_f32 v[222:223], v[222:223], v[238:239]
  s_waitcnt vmcnt(0)
  v_lshlrev_b32 v236, 16, v182
  v_and_b32 v237, 0xffff0000, v182
  v_pk_add_f32 v[220:221], v[220:221], v[236:237]
  v_lshlrev_b32 v238, 16, v183
  v_and_b32 v239, 0xffff0000, v183
  v_pk_add_f32 v[222:223], v[222:223], v[238:239]
  v_cvt_pk_bf16_f32 v236, v220, v221
  v_cvt_pk_bf16_f32 v237, v222, v223
  buffer_store_dwordx2 v[236:237], v5, s[36:39], s59 offen
L_FIN:
L_END:
  s_endpgm
L_HOT_END:
L_B_PUBS:
  v_cvt_pk_bf16_f32 v104, v8, v9
  v_cvt_pk_bf16_f32 v105, v10, v11
  v_cvt_pk_bf16_f32 v106, v12, v13
  v_cvt_pk_bf16_f32 v107, v14, v15
  buffer_store_dwordx4 v[104:107], v6, s[44:47], s58 offen offset:0 sc1
  v_cvt_pk_bf16_f32 v108, v16, v17
  v_cvt_pk_bf16_f32 v109, v18, v19
  v_cvt_pk_bf16_f32 v110, v20, v21
  v_cvt_pk_bf16_f32 v111, v22, v23
  buffer_store_dwordx4 v[108:111], v6, s[44:47], s58 offen offset:1024 sc1
  v_cvt_pk_bf16_f32 v112, v24, v25
  v_cvt_pk_bf16_f32 v113, v26, v27
  v_cvt_pk_bf16_f32 v114, v28, v29
  v_cvt_pk_bf16_f32 v115, v30, v31
  buffer_store_dwordx4 v[112:115], v6, s[44:47], s58 offen offset:2048 sc1
  v_cvt_pk_bf16_f32 v116, v32, v33
  v_cvt_pk_bf16_f32 v117, v34, v35
  v_cvt_pk_bf16_f32 v118, v36, v37
  v_cvt_pk_bf16_f32 v119, v38, v39
  buffer_store_dwordx4 v[116:119], v6, s[44:47], s58 offen offset:3072 sc1
  s_add_u32 s58, s58, 4096
  v_cvt_pk_bf16_f32 v120, v40, v41
  v_cvt_pk_bf16_f32 v121, v42, v43
  v_cvt_pk_bf16_f32 v122, v44, v45
  v_cvt_pk_bf16_f32 v123, v46, v47
  buffer_store_dwordx4 v[120:123], v6, s[44:47], s58 offen offset:0 sc1
  v_cvt_pk_bf16_f32 v124, v48, v49
  v_cvt_pk_bf16_f32 v125, v50, v51
  v_cvt_pk_bf16_f32 v126, v52, v53
  v_cvt_pk_bf16_f32 v127, v54, v55
  buffer_store_dwordx4 v[124:127], v6, s[44:47], s58 offen offset:1024 sc1
  v_cvt_pk_bf16_f32 v128, v56, v57
  v_cvt_pk_bf16_f32 v129, v58, v59
  v_cvt_pk_bf16_f32 v130, v60, v61
  v_cvt_pk_bf16_f32 v131, v62, v63
  buffer_store_dwordx4 v[128:131], v6, s[44:47], s58 offen offset:2048 sc1
  v_cvt_pk_bf16_f32 v132, v64, v65
  v_cvt_pk_bf16_f32 v133, v66, v67
  v_cvt_pk_bf16_f32 v134, v68, v69
  v_cvt_pk_bf16_f32 v135, v70, v71
  buffer_store_dwordx4 v[132:135], v6, s[44:47], s58 offen offset:3072 sc1
  s_add_u32 s58, s58, 4096
  v_cvt_pk_bf16_f32 v136, v72, v73
  v_cvt_pk_bf16_f32 v137, v74, v75
  v_cvt_pk_bf16_f32 v138, v76, v77
  v_cvt_pk_bf16_f32 v139, v78, v79
  buffer_store_dwordx4 v[136:139], v6, s[44:47], s58 offen offset:0 sc1
  v_cvt_pk_bf16_f32 v140, v80, v81
  v_cvt_pk_bf16_f32 v141, v82, v83
  v_cvt_pk_bf16_f32 v142, v84, v85
  v_cvt_pk_bf16_f32 v143, v86, v87
  buffer_store_dwordx4 v[140:143], v6, s[44:47], s58 offen offset:1024 sc1
  v_cvt_pk_bf16_f32 v144, v88, v89
  v_cvt_pk_bf16_f32 v145, v90, v91
  v_cvt_pk_bf16_f32 v146, v92, v93
  v_cvt_pk_bf16_f32 v147, v94, v95
  buffer_store_dwordx4 v[144:147], v6, s[44:47], s58 offen offset:2048 sc1
  v_cvt_pk_bf16_f32 v148, v96, v97
  v_cvt_pk_bf16_f32 v149, v98, v99
  v_cvt_pk_bf16_f32 v150, v100, v101
  v_cvt_pk_bf16_f32 v151, v102, v103
  buffer_store_dwordx4 v[148:151], v6, s[44:47], s58 offen offset:3072 sc1
  v_sub_f32 v216, 0, v212
  v_mov_b32 v217, v192
  v_sub_f32 v218, 0, v213
  v_mov_b32 v219, v196
  v_sub_f32 v220, 0, v214
  v_mov_b32 v221, v200
  s_mov_b64 exec, 0xffff
  buffer_store_dwordx2 v[216:217], v224, s[44:47], s57 offen offset:0 sc1
  buffer_store_dwordx2 v[218:219], v224, s[44:47], s57 offen offset:128 sc1
  buffer_store_dwordx2 v[220:221], v224, s[44:47], s57 offen offset:256 sc1
  s_mov_b64 exec, -1
  s_barrier
  ds_read_b32 v5, v4 offset:8
  s_waitcnt lgkmcnt(0)
  v_readfirstlane_b32 s54, v5
  s_cmp_lg_u32 s54, 0
  s_cbranch_scc0 L_B_FLAGS
  s_cmp_lg_u32 s73, 0
  s_cbranch_scc0 L_B_SAFE
L_B_FLAGS:
  s_waitcnt vmcnt(0)
  s_mov_b64 exec, 1
  buffer_store_dwordx2 v[222:223], v7, s[44:47], s56 offen sc1
  s_mov_b64 exec, -1
  s_branch L_TAIL
L_T_OPUBS:
  buffer_store_dwordx4 v[168:171], v6, s[44:47], s59 offen sc1
  buffer_store_dwordx4 v[172:175], v6, s[44:47], s59 offen offset:1024 sc1
  s_waitcnt vmcnt(0)
  s_mov_b64 exec, 1
  ds_add_rtn_u32 v236, v4, v5 offset:24
  s_waitcnt lgkmcnt(0)
  v_readfirstlane_b32 s54, v236
  s_cmp_lg_u32 s54, 5
  s_cbranch_scc1 L_T_ONOFS
  buffer_store_dwordx2 v[200:201], v7, s[44:47], s58 offen offset:256 sc1
L_T_ONOFS:
  s_mov_b64 exec, -1
  s_branch L_T_NOCOMB
  .p2align 6
L_A_SAFE:
  s_mov_b32 s73, 1
  s_waitcnt vmcnt(0)
  v_mov_b32 v96, 0
  v_mov_b32 v97, 0
  v_mov_b32 v98, 0
  v_mov_b32 v99, 0
  v_mov_b32 v100, 0
  v_mov_b32 v101, 0
  v_mov_b32 v102, 0
  v_mov_b32 v103, 0
  v_mov_b32 v104, 0
  v_mov_b32 v105, 0
  v_mov_b32 v106, 0
  v_mov_b32 v107, 0
  v_mov_b32 v124, v130
  s_mov_b32 s62, -1.0
  s_mov_b32 s63, 0xff800000
  s_mov_b32 s64, 0
  s_setprio 1
  s_barrier
  ds_read_b128 v[8:11], v124 offset:0
  ds_read_b128 v[12:15], v124 offset:512
  ds_read_b128 v[16:19], v124 offset:1024
  ds_read_b128 v[20:23], v124 offset:1536
  ds_read_b128 v[24:27], v124 offset:4096
  ds_read_b128 v[28:31], v124 offset:4608
  ds_read_b128 v[32:35], v124 offset:5120
  ds_read_b128 v[36:39], v124 offset:5632
  s_waitcnt lgkmcnt(0)
  v_mfma_f32_16x16x32_bf16 v[72:75], v[8:11], v[136:139], v[96:99]
  v_mfma_f32_16x16x32_bf16 v[72:75], v[12:15], v[140:143], v[72:75]
  v_mfma_f32_16x16x32_bf16 v[72:75], v[16:19], v[144:147], v[72:75]
  v_mfma_f32_16x16x32_bf16 v[72:75], v[20:23], v[148:151], v[72:75]
  v_mfma_f32_16x16x32_bf16 v[76:79], v[24:27], v[136:139], v[96:99]
  v_mfma_f32_16x16x32_bf16 v[76:79], v[28:31], v[140:143], v[76:79]
  v_mfma_f32_16x16x32_bf16 v[76:79], v[32:35], v[144:147], v[76:79]
  v_mfma_f32_16x16x32_bf16 v[76:79], v[36:39], v[148:151], v[76:79]
  s_nop 3
  s_branch L_AS_ENTRY
L_AS_LOOP:
  s_waitcnt lgkmcnt(1)
  v_mfma_f32_16x16x32_bf16 v[72:75], v[8:11], v[136:139], v[96:99]
  v_exp_f32 v108, v88
  v_exp_f32 v109, v89
  v_mfma_f32_16x16x32_bf16 v[72:75], v[12:15], v[140:143], v[72:75]
  v_exp_f32 v110, v90
  v_exp_f32 v111, v91
  s_waitcnt lgkmcnt(0)
  s_barrier
  v_mfma_f32_16x16x32_bf16 v[72:75], v[16:19], v[144:147], v[72:75]
  v_add_f32 v120, v108, v109
  v_add_f32 v121, v110, v111
  v_cvt_pk_bf16_f32 v116, v108, v109
  v_cvt_pk_bf16_f32 v117, v110, v111
  v_mfma_f32_16x16x32_bf16 v[72:75], v[20:23], v[148:151], v[72:75]
  v_exp_f32 v112, v92
  v_exp_f32 v113, v93
  v_mfma_f32_16x16x32_bf16 v[76:79], v[24:27], v[136:139], v[96:99]
  v_exp_f32 v114, v94
  v_exp_f32 v115, v95
  v_mfma_f32_16x16x32_bf16 v[76:79], v[28:31], v[140:143], v[76:79]
  v_add_f32 v122, v112, v113
  v_add_f32 v123, v114, v115
  v_cvt_pk_bf16_f32 v118, v112, v113
  v_cvt_pk_bf16_f32 v119, v114, v115
  v_mfma_f32_16x16x32_bf16 v[76:79], v[32:35], v[144:147], v[76:79]
  v_add_f32 v120, v120, v121
  v_add_f32 v122, v122, v123
  v_add_f32 v120, v120, v122
  v_cmp_nge_f32 vcc, s62, v120
  v_mfma_f32_16x16x32_bf16 v[76:79], v[36:39], v[148:151], v[76:79]
  s_cbranch_vccnz L_AST_s5
L_ARET_s5:
  ds_write_b128 v125, v[116:119] offset:5120
L_AS_ENTRY:
  v_mfma_f32_16x16x32_bf16 v[80:83], v[8:11], v[152:155], v[100:103]
  v_exp_f32 v108, v72
  v_exp_f32 v109, v73
  v_mfma_f32_16x16x32_bf16 v[80:83], v[12:15], v[156:159], v[80:83]
  v_exp_f32 v110, v74
  v_exp_f32 v111, v75
  ds_read_b128 v[40:43], v124 offset:8192
  v_mfma_f32_16x16x32_bf16 v[80:83], v[16:19], v[160:163], v[80:83]
  v_add_f32 v120, v108, v109
  v_add_f32 v121, v110, v111
  v_cvt_pk_bf16_f32 v116, v108, v109
  v_cvt_pk_bf16_f32 v117, v110, v111
  ds_read_b128 v[44:47], v124 offset:8704
  v_mfma_f32_16x16x32_bf16 v[80:83], v[20:23], v[164:167], v[80:83]
  v_exp_f32 v112, v76
  v_exp_f32 v113, v77
  ds_read_b128 v[48:51], v124 offset:9216
  v_mfma_f32_16x16x32_bf16 v[84:87], v[24:27], v[152:155], v[100:103]
  v_exp_f32 v114, v78
  v_exp_f32 v115, v79
  ds_read_b128 v[52:55], v124 offset:9728
  v_mfma_f32_16x16x32_bf16 v[84:87], v[28:31], v[156:159], v[84:87]
  v_add_f32 v122, v112, v113
  v_add_f32 v123, v114, v115
  v_cvt_pk_bf16_f32 v118, v112, v113
  v_cvt_pk_bf16_f32 v119, v114, v115
  v_mfma_f32_16x16x32_bf16 v[84:87], v[32:35], v[160:163], v[84:87]
  v_add_f32 v120, v120, v121
  v_add_f32 v122, v122, v123
  v_add_f32 v120, v120, v122
  v_cmp_nge_f32 vcc, s62, v120
  v_mfma_f32_16x16x32_bf16 v[84:87], v[36:39], v[164:167], v[84:87]
  s_cbranch_vccnz L_AST_s0
L_ARET_s0:
  ds_write_b128 v125, v[116:119] offset:0
  v_mfma_f32_16x16x32_bf16 v[88:91], v[8:11], v[168:171], v[104:107]
  v_exp_f32 v108, v80
  v_exp_f32 v109, v81
  v_mfma_f32_16x16x32_bf16 v[88:91], v[12:15], v[172:175], v[88:91]
  v_exp_f32 v110, v82
  v_exp_f32 v111, v83
  ds_read_b128 v[56:59], v124 offset:12288
  v_mfma_f32_16x16x32_bf16 v[88:91], v[16:19], v[176:179], v[88:91]
  v_add_f32 v120, v108, v109
  v_add_f32 v121, v110, v111
  v_cvt_pk_bf16_f32 v116, v108, v109
  v_cvt_pk_bf16_f32 v117, v110, v111
  ds_read_b128 v[60:63], v124 offset:12800
  v_mfma_f32_16x16x32_bf16 v[88:91], v[20:23], v[180:183], v[88:91]
  v_exp_f32 v112, v84
  v_exp_f32 v113, v85
  ds_read_b128 v[64:67], v124 offset:13312
  v_mfma_f32_16x16x32_bf16 v[92:95], v[24:27], v[168:171], v[104:107]
  v_exp_f32 v114, v86
  v_exp_f32 v115, v87
  ds_read_b128 v[68:71], v124 offset:13824
  v_mfma_f32_16x16x32_bf16 v[92:95], v[28:31], v[172:175], v[92:95]
  v_add_f32 v122, v112, v113
  v_add_f32 v123, v114, v115
  v_cvt_pk_bf16_f32 v118, v112, v113
  v_cvt_pk_bf16_f32 v119, v114, v115
  v_mfma_f32_16x16x32_bf16 v[92:95], v[32:35], v[176:179], v[92:95]
  v_add_f32 v120, v120, v121
  v_add_f32 v122, v122, v123
  v_add_f32 v120, v120, v122
  v_cmp_nge_f32 vcc, s62, v120
  v_mfma_f32_16x16x32_bf16 v[92:95], v[36:39], v[180:183], v[92:95]
  s_cbranch_vccnz L_AST_s1
L_ARET_s1:
  ds_write_b128 v125, v[116:119] offset:1024
  v_add_u32 v124, 0x4000, v124
  v_and_b32 v124, 0xffff, v124
  s_waitcnt lgkmcnt(1)
  v_mfma_f32_16x16x32_bf16 v[72:75], v[40:43], v[136:139], v[96:99]
  v_exp_f32 v108, v88
  v_exp_f32 v109, v89
  v_mfma_f32_16x16x32_bf16 v[72:75], v[44:47], v[140:143], v[72:75]
  v_exp_f32 v110, v90
  v_exp_f32 v111, v91
  s_waitcnt lgkmcnt(0)
  s_barrier
  v_mfma_f32_16x16x32_bf16 v[72:75], v[48:51], v[144:147], v[72:75]
  v_add_f32 v120, v108, v109
  v_add_f32 v121, v110, v111
  v_cvt_pk_bf16_f32 v116, v108, v109
  v_cvt_pk_bf16_f32 v117, v110, v111
  v_mfma_f32_16x16x32_bf16 v[72:75], v[52:55], v[148:151], v[72:75]
  v_exp_f32 v112, v92
  v_exp_f32 v113, v93
  v_mfma_f32_16x16x32_bf16 v[76:79], v[56:59], v[136:139], v[96:99]
  v_exp_f32 v114, v94
  v_exp_f32 v115, v95
  v_mfma_f32_16x16x32_bf16 v[76:79], v[60:63], v[140:143], v[76:79]
  v_add_f32 v122, v112, v113
  v_add_f32 v123, v114, v115
  v_cvt_pk_bf16_f32 v118, v112, v113
  v_cvt_pk_bf16_f32 v119, v114, v115
  v_mfma_f32_16x16x32_bf16 v[76:79], v[64:67], v[144:147], v[76:79]
  v_add_f32 v120, v120, v121
  v_add_f32 v122, v122, v123
  v_add_f32 v120, v120, v122
  v_cmp_nge_f32 vcc, s62, v120
  v_mfma_f32_16x16x32_bf16 v[76:79], v[68:71], v[148:151], v[76:79]
  s_cbranch_vccnz L_AST_s2
L_ARET_s2:
  ds_write_b128 v125, v[116:119] offset:2048
  s_mov_b32 s62, 0x46800000
  s_mov_b32 s63, 0
  v_mfma_f32_16x16x32_bf16 v[80:83], v[40:43], v[152:155], v[100:103]
  v_exp_f32 v108, v72
  v_exp_f32 v109, v73
  v_mfma_f32_16x16x32_bf16 v[80:83], v[44:47], v[156:159], v[80:83]
  v_exp_f32 v110, v74
  v_exp_f32 v111, v75
  ds_read_b128 v[8:11], v124 offset:0
  v_mfma_f32_16x16x32_bf16 v[80:83], v[48:51], v[160:163], v[80:83]
  v_add_f32 v120, v108, v109
  v_add_f32 v121, v110, v111
  v_cvt_pk_bf16_f32 v116, v108, v109
  v_cvt_pk_bf16_f32 v117, v110, v111
  ds_read_b128 v[12:15], v124 offset:512
  v_mfma_f32_16x16x32_bf16 v[80:83], v[52:55], v[164:167], v[80:83]
  v_exp_f32 v112, v76
  v_exp_f32 v113, v77
  ds_read_b128 v[16:19], v124 offset:1024
  v_mfma_f32_16x16x32_bf16 v[84:87], v[56:59], v[152:155], v[100:103]
  v_exp_f32 v114, v78
  v_exp_f32 v115, v79
  ds_read_b128 v[20:23], v124 offset:1536
  v_mfma_f32_16x16x32_bf16 v[84:87], v[60:63], v[156:159], v[84:87]
  v_add_f32 v122, v112, v113
  v_add_f32 v123, v114, v115
  v_cvt_pk_bf16_f32 v118, v112, v113
  v_cvt_pk_bf16_f32 v119, v114, v115
  v_mfma_f32_16x16x32_bf16 v[84:87], v[64:67], v[160:163], v[84:87]
  v_add_f32 v120, v120, v121
  v_add_f32 v122, v122, v123
  v_add_f32 v120, v120, v122
  v_cmp_nge_f32 vcc, s62, v120
  v_mfma_f32_16x16x32_bf16 v[84:87], v[68:71], v[164:167], v[84:87]
  s_cbranch_vccnz L_AST_s3
L_ARET_s3:
  ds_write_b128 v125, v[116:119] offset:3072
  v_mfma_f32_16x16x32_bf16 v[88:91], v[40:43], v[168:171], v[104:107]
  v_exp_f32 v108, v80
  v_exp_f32 v109, v81
  v_mfma_f32_16x16x32_bf16 v[88:91], v[44:47], v[172:175], v[88:91]
  v_exp_f32 v110, v82
  v_exp_f32 v111, v83
  ds_read_b128 v[24:27], v124 offset:4096
  v_mfma_f32_16x16x32_bf16 v[88:91], v[48:51], v[176:179], v[88:91]
  v_add_f32 v120, v108, v109
  v_add_f32 v121, v110, v111
  v_cvt_pk_bf16_f32 v116, v108, v109
  v_cvt_pk_bf16_f32 v117, v110, v111
  ds_read_b128 v[28:31], v124 offset:4608
  v_mfma_f32_16x16x32_bf16 v[88:91], v[52:55], v[180:183], v[88:91]
  v_exp_f32 v112, v84
  v_exp_f32 v113, v85
  ds_read_b128 v[32:35], v124 offset:5120
  v_mfma_f32_16x16x32_bf16 v[92:95], v[56:59], v[168:171], v[104:107]
  v_exp_f32 v114, v86
  v_exp_f32 v115, v87
  ds_read_b128 v[36:39], v124 offset:5632
  v_mfma_f32_16x16x32_bf16 v[92:95], v[60:63], v[172:175], v[92:95]
  v_add_f32 v122, v112, v113
  v_add_f32 v123, v114, v115
  v_cvt_pk_bf16_f32 v118, v112, v113
  v_cvt_pk_bf16_f32 v119, v114, v115
  v_mfma_f32_16x16x32_bf16 v[92:95], v[64:67], v[176:179], v[92:95]
  v_add_f32 v120, v120, v121
  v_add_f32 v122, v122, v123
  v_add_f32 v120, v120, v122
  v_cmp_nge_f32 vcc, s62, v120
  v_mfma_f32_16x16x32_bf16 v[92:95], v[68:71], v[180:183], v[92:95]
  s_cbranch_vccnz L_AST_s4
L_ARET_s4:
  ds_write_b128 v125, v[116:119] offset:4096
  s_add_u32 s64, s64, 1
  s_cmp_lt_u32 s64, 8
  s_cbranch_scc1 L_AS_LOOP
  s_nop 7
  v_exp_f32 v108, v88
  v_exp_f32 v109, v89
  v_exp_f32 v110, v90
  v_exp_f32 v111, v91
  s_waitcnt lgkmcnt(0)
  s_barrier
  v_add_f32 v120, v108, v109
  v_add_f32 v121, v110, v111
  v_cvt_pk_bf16_f32 v116, v108, v109
  v_cvt_pk_bf16_f32 v117, v110, v111
  v_exp_f32 v112, v92
  v_exp_f32 v113, v93
  v_exp_f32 v114, v94
  v_exp_f32 v115, v95
  v_add_f32 v122, v112, v113
  v_add_f32 v123, v114, v115
  v_cvt_pk_bf16_f32 v118, v112, v113
  v_cvt_pk_bf16_f32 v119, v114, v115
  v_add_f32 v120, v120, v121
  v_add_f32 v122, v122, v123
  v_add_f32 v120, v120, v122
  v_cmp_nge_f32 vcc, s62, v120
  s_cbranch_vccnz L_AST_fin
L_ARET_fin:
  ds_write_b128 v125, v[116:119] offset:5120
  s_branch L_A_FINISH
L_AST_s5:
  s_call_b64 s[60:61], L_ARARE2
  ds_write_b32 v126, v129 offset:1280
  s_branch L_ARET_s5
L_AST_s0:
  s_call_b64 s[60:61], L_ARARE0
  ds_write_b32 v126, v129 offset:0
  s_branch L_ARET_s0
L_AST_s1:
  s_call_b64 s[60:61], L_ARARE1
  ds_write_b32 v126, v129 offset:256
  s_branch L_ARET_s1
L_AST_s2:
  s_call_b64 s[60:61], L_ARARE2
  ds_write_b32 v126, v129 offset:512
  s_branch L_ARET_s2
L_AST_s3:
  s_call_b64 s[60:61], L_ARARE0
  ds_write_b32 v126, v129 offset:768
  s_branch L_ARET_s3
L_AST_s4:
  s_call_b64 s[60:61], L_ARARE1
  ds_write_b32 v126, v129 offset:1024
  s_branch L_ARET_s4
L_AST_fin:
  s_call_b64 s[60:61], L_ARARE2
  ds_write_b32 v126, v129 offset:1280
  s_branch L_ARET_fin
L_ARARE0:
  v_max3_f32 v127, v72, v73, v74
  v_max3_f32 v127, v127, v75, v76
  v_max3_f32 v127, v127, v77, v78
  v_max_f32 v127, v127, v79
  v_mov_b32 v128, v127
  s_nop 1
  v_permlane32_swap_b32 v127, v128
  v_max_f32 v127, v127, v128
  v_mov_b32 v128, v127
  s_nop 1
  v_permlane16_swap_b32 v127, v128
  v_max3_f32 v127, v127, v128, s63
  v_max_f32 v128, 0, v127
  v_exp_f32 v129, -v128
  v_sub_f32 v96, v96, v127
  v_sub_f32 v97, v97, v127
  v_sub_f32 v98, v98, v127
  v_sub_f32 v99, v99, v127
  v_sub_f32 v108, v72, v127
  v_sub_f32 v109, v73, v127
  v_sub_f32 v110, v74, v127
  v_sub_f32 v111, v75, v127
  v_sub_f32 v112, v76, v127
  v_sub_f32 v113, v77, v127
  v_sub_f32 v114, v78, v127
  v_sub_f32 v115, v79, v127
  v_exp_f32 v108, v108
  v_exp_f32 v109, v109
  v_exp_f32 v110, v110
  v_exp_f32 v111, v111
  v_exp_f32 v112, v112
  v_exp_f32 v113, v113
  v_exp_f32 v114, v114
  v_exp_f32 v115, v115
  s_nop 0
  v_cvt_pk_bf16_f32 v116, v108, v109
  v_cvt_pk_bf16_f32 v117, v110, v111
  v_cvt_pk_bf16_f32 v118, v112, v113
  v_cvt_pk_bf16_f32 v119, v114, v115
  v_or_b32 v116, 0x80000000, v116
  s_setpc_b64 s[60:61]
L_ARARE1:
  v_max3_f32 v127, v80, v81, v82
  v_max3_f32 v127, v127, v83, v84
  v_max3_f32 v127, v127, v85, v86
  v_max_f32 v127, v127, v87
  v_mov_b32 v128, v127
  s_nop 1
  v_permlane32_swap_b32 v127, v128
  v_max_f32 v127, v127, v128
  v_mov_b32 v128, v127
  s_nop 1
  v_permlane16_swap_b32 v127, v128
  v_max3_f32 v127, v127, v128, s63
  v_max_f32 v128, 0, v127
  v_exp_f32 v129, -v128
  v_sub_f32 v100, v100, v127
  v_sub_f32 v101, v101, v127
  v_sub_f32 v102, v102, v127
  v_sub_f32 v103, v103, v127
  v_sub_f32 v108, v80, v127
  v_sub_f32 v109, v81, v127
  v_sub_f32 v110, v82, v127
  v_sub_f32 v111, v83, v127
  v_sub_f32 v112, v84, v127
  v_sub_f32 v113, v85, v127
  v_sub_f32 v114, v86, v127
  v_sub_f32 v115, v87, v127
  v_exp_f32 v108, v108
  v_exp_f32 v109, v109
  v_exp_f32 v110, v110
  v_exp_f32 v111, v111
  v_exp_f32 v112, v112
  v_exp_f32 v113, v113
  v_exp_f32 v114, v114
  v_exp_f32 v115, v115
  s_nop 0
  v_cvt_pk_bf16_f32 v116, v108, v109
  v_cvt_pk_bf16_f32 v117, v110, v111
  v_cvt_pk_bf16_f32 v118, v112, v113
  v_cvt_pk_bf16_f32 v119, v114, v115
  v_or_b32 v116, 0x80000000, v116
  s_setpc_b64 s[60:61]
L_ARARE2:
  v_max3_f32 v127, v88, v89, v90
  v_max3_f32 v127, v127, v91, v92
  v_max3_f32 v127, v127, v93, v94
  v_max_f32 v127, v127, v95
  v_mov_b32 v128, v127
  s_nop 1
  v_permlane32_swap_b32 v127, v128
  v_max_f32 v127, v127, v128
  v_mov_b32 v128, v127
  s_nop 1
  v_permlane16_swap_b32 v127, v128
  v_max3_f32 v127, v127, v128, s63
  v_max_f32 v128, 0, v127
  v_exp_f32 v129, -v128
  v_sub_f32 v104, v104, v127
  v_sub_f32 v105, v105, v127
  v_sub_f32 v106, v106, v127
  v_sub_f32 v107, v107, v127
  v_sub_f32 v108, v88, v127
  v_sub_f32 v109, v89, v127
  v_sub_f32 v110, v90, v127
  v_sub_f32 v111, v91, v127
  v_sub_f32 v112, v92, v127
  v_sub_f32 v113, v93, v127
  v_sub_f32 v114, v94, v127
  v_sub_f32 v115, v95, v127
  v_exp_f32 v108, v108
  v_exp_f32 v109, v109
  v_exp_f32 v110, v110
  v_exp_f32 v111, v111
  v_exp_f32 v112, v112
  v_exp_f32 v113, v113
  v_exp_f32 v114, v114
  v_exp_f32 v115, v115
  s_nop 0
  v_cvt_pk_bf16_f32 v116, v108, v109
  v_cvt_pk_bf16_f32 v117, v110, v111
  v_cvt_pk_bf16_f32 v118, v112, v113
  v_cvt_pk_bf16_f32 v119, v114, v115
  v_or_b32 v116, 0x80000000, v116
  s_setpc_b64 s[60:61]
L_B_SAFE:
  s_mov_b32 s73, 1
  s_waitcnt vmcnt(0)
  s_mov_b32 s20, s6
  s_and_b32 s21, s7, 0xffff
  s_mov_b32 s22, 0x2000000
  s_mov_b32 s23, 0x20000
  s_mov_b32 s24, s8
  s_and_b32 s25, s9, 0xffff
  s_mov_b32 s26, 0x2000000
  s_mov_b32 s27, 0x20000
  v_mov_b32 v184, v208
  v_mov_b32 v185, v209
  s_lshl_b32 s65, s51, 19
  s_lshl_b32 s54, s50, 17
  s_add_u32 s65, s65, s54
  s_lshl_b32 s54, s53, 11
  s_add_u32 s65, s65, s54
  s_mov_b32 s66, s65
  s_add_u32 s67, s54, 0x0
  s_add_u32 s68, s54, 0x10000
  s_mov_b32 s72, 8
  s_movk_i32 s70, 0x2000
  s_movk_i32 s71, 0x2000
  v_mov_b32 v187, v210
  v_xor_b32 v188, 32, v210
  v_mov_b32 v8, 0
  v_mov_b32 v9, 0
  v_mov_b32 v10, 0
  v_mov_b32 v11, 0
  v_mov_b32 v12, 0
  v_mov_b32 v13, 0
  v_mov_b32 v14, 0
  v_mov_b32 v15, 0
  v_mov_b32 v16, 0
  v_mov_b32 v17, 0
  v_mov_b32 v18, 0
  v_mov_b32 v19, 0
  v_mov_b32 v20, 0
  v_mov_b32 v21, 0
  v_mov_b32 v22, 0
  v_mov_b32 v23, 0
  v_mov_b32 v24, 0
  v_mov_b32 v25, 0
  v_mov_b32 v26, 0
  v_mov_b32 v27, 0
  v_mov_b32 v28, 0
  v_mov_b32 v29, 0
  v_mov_b32 v30, 0
  v_mov_b32 v31, 0
  v_mov_b32 v32, 0
  v_mov_b32 v33, 0
  v_mov_b32 v34, 0
  v_mov_b32 v35, 0
  v_mov_b32 v36, 0
  v_mov_b32 v37, 0
  v_mov_b32 v38, 0
  v_mov_b32 v39, 0
  v_mov_b32 v40, 0
  v_mov_b32 v41, 0
  v_mov_b32 v42, 0
  v_mov_b32 v43, 0
  v_mov_b32 v44, 0
  v_mov_b32 v45, 0
  v_mov_b32 v46, 0
  v_mov_b32 v47, 0
  v_mov_b32 v48, 0
  v_mov_b32 v49, 0
  v_mov_b32 v50, 0
  v_mov_b32 v51, 0
  v_mov_b32 v52, 0
  v_mov_b32 v53, 0
  v_mov_b32 v54, 0
  v_mov_b32 v55, 0
  v_mov_b32 v56, 0
  v_mov_b32 v57, 0
  v_mov_b32 v58, 0
  v_mov_b32 v59, 0
  v_mov_b32 v60, 0
  v_mov_b32 v61, 0
  v_mov_b32 v62, 0
  v_mov_b32 v63, 0
  v_mov_b32 v64, 0
  v_mov_b32 v65, 0
  v_mov_b32 v66, 0
  v_mov_b32 v67, 0
  v_mov_b32 v68, 0
  v_mov_b32 v69, 0
  v_mov_b32 v70, 0
  v_mov_b32 v71, 0
  v_mov_b32 v72, 0
  v_mov_b32 v73, 0
  v_mov_b32 v74, 0
  v_mov_b32 v75, 0
  v_mov_b32 v76, 0
  v_mov_b32 v77, 0
  v_mov_b32 v78, 0
  v_mov_b32 v79, 0
  v_mov_b32 v80, 0
  v_mov_b32 v81, 0
  v_mov_b32 v82, 0
  v_mov_b32 v83, 0
  v_mov_b32 v84, 0
  v_mov_b32 v85, 0
  v_mov_b32 v86, 0
  v_mov_b32 v87, 0
  v_mov_b32 v88, 0
  v_mov_b32 v89, 0
  v_mov_b32 v90, 0
  v_mov_b32 v91, 0
  v_mov_b32 v92, 0
  v_mov_b32 v93, 0
  v_mov_b32 v94, 0
  v_mov_b32 v95, 0
  v_mov_b32 v96, 0
  v_mov_b32 v97, 0
  v_mov_b32 v98, 0
  v_mov_b32 v99, 0
  v_mov_b32 v100, 0
  v_mov_b32 v101, 0
  v_mov_b32 v102, 0
  v_mov_b32 v103, 0
  v_mov_b32 v192, 0
  v_mov_b32 v193, 0
  v_mov_b32 v194, 0
  v_mov_b32 v195, 0
  v_mov_b32 v196, 0
  v_mov_b32 v197, 0
  v_mov_b32 v198, 0
  v_mov_b32 v199, 0
  v_mov_b32 v200, 0
  v_mov_b32 v201, 0
  v_mov_b32 v202, 0
  v_mov_b32 v203, 0
  s_mov_b32 m0, s67
  s_nop 0
  buffer_load_dwordx4 v184, s[20:23], s65 offen nt lds
  s_add_u32 m0, s67, 896
  s_add_u32 s67, s67, 8192
  buffer_load_dwordx4 v184, s[20:23], s65 offen offset:128 nt lds
  s_add_u32 s65, s65, s70
  s_bitset0_b32 s67, 16
  s_mov_b32 m0, s67
  s_nop 0
  buffer_load_dwordx4 v184, s[20:23], s65 offen nt lds
  s_add_u32 m0, s67, 896
  s_add_u32 s67, s67, 8192
  buffer_load_dwordx4 v184, s[20:23], s65 offen offset:128 nt lds
  s_add_u32 s65, s65, s70
  s_bitset0_b32 s67, 16
  s_mov_b32 m0, s67
  s_nop 0
  buffer_load_dwordx4 v184, s[20:23], s65 offen nt lds
  s_add_u32 m0, s67, 896
  s_add_u32 s67, s67, 8192
  buffer_load_dwordx4 v184, s[20:23], s65 offen offset:128 nt lds
  s_add_u32 s65, s65, s70
  s_bitset0_b32 s67, 16
  s_mov_b32 m0, s68
  s_nop 0
  buffer_load_dwordx4 v185, s[24:27], s66 offen nt lds
  s_add_u32 m0, s68, 896
  s_add_u32 s68, s68, 8192
  buffer_load_dwordx4 v185, s[24:27], s66 offen offset:128 nt lds
  s_add_u32 s66, s66, s71
  s_bitset1_b32 s68, 16
  s_bitset0_b32 s68, 17
  s_mov_b32 m0, s67
  s_nop 0
  buffer_load_dwordx4 v184, s[20:23], s65 offen nt lds
  s_add_u32 m0, s67, 896
  s_add_u32 s67, s67, 8192
  buffer_load_dwordx4 v184, s[20:23], s65 offen offset:128 nt lds
  s_add_u32 s65, s65, s70
  s_bitset0_b32 s67, 16
  s_mov_b32 m0, s68
  s_nop 0
  buffer_load_dwordx4 v185, s[24:27], s66 offen nt lds
  s_add_u32 m0, s68, 896
  s_add_u32 s68, s68, 8192
  buffer_load_dwordx4 v185, s[24:27], s66 offen offset:128 nt lds
  s_add_u32 s66, s66, s71
  s_bitset1_b32 s68, 16
  s_bitset0_b32 s68, 17
  s_mov_b32 m0, s67
  s_nop 0
  buffer_load_dwordx4 v184, s[20:23], s65 offen nt lds
  s_add_u32 m0, s67, 896
  s_add_u32 s67, s67, 8192
  buffer_load_dwordx4 v184, s[20:23], s65 offen offset:128 nt lds
  s_add_u32 s65, s65, s70
  s_bitset0_b32 s67, 16
  s_mov_b32 m0, s68
  s_nop 0
  buffer_load_dwordx4 v185, s[24:27], s66 offen nt lds
  s_add_u32 m0, s68, 896
  s_add_u32 s68, s68, 8192
  buffer_load_dwordx4 v185, s[24:27], s66 offen offset:128 nt lds
  s_add_u32 s66, s66, s71
  s_bitset1_b32 s68, 16
  s_bitset0_b32 s68, 17
  s_mov_b32 m0, s68
  s_nop 0
  buffer_load_dwordx4 v185, s[24:27], s66 offen nt lds
  s_add_u32 m0, s68, 896
  s_add_u32 s68, s68, 8192
  buffer_load_dwordx4 v185, s[24:27], s66 offen offset:128 nt lds
  s_add_u32 s66, s66, s71
  s_bitset1_b32 s68, 16
  s_bitset0_b32 s68, 17
  s_mov_b32 m0, s68
  s_nop 0
  buffer_load_dwordx4 v185, s[24:27], s66 offen nt lds
  s_add_u32 m0, s68, 896
  s_add_u32 s68, s68, 8192
  buffer_load_dwordx4 v185, s[24:27], s66 offen offset:128 nt lds
  s_add_u32 s66, s66, s71
  s_bitset1_b32 s68, 16
  s_bitset0_b32 s68, 17
  s_mov_b32 m0, s67
  s_nop 0
  buffer_load_dwordx4 v184, s[20:23], s65 offen nt lds
  s_add_u32 m0, s67, 896
  s_add_u32 s67, s67, 8192
  buffer_load_dwordx4 v184, s[20:23], s65 offen offset:128 nt lds
  s_add_u32 s65, s65, s70
  s_bitset0_b32 s67, 16
  s_mov_b32 m0, s67
  s_nop 0
  buffer_load_dwordx4 v184, s[20:23], s65 offen nt lds
  s_add_u32 m0, s67, 896
  s_add_u32 s67, s67, 8192
  buffer_load_dwordx4 v184, s[20:23], s65 offen offset:128 nt lds
  s_add_u32 s65, s65, s70
  s_bitset0_b32 s67, 16
  s_mov_b32 m0, s67
  s_nop 0
  buffer_load_dwordx4 v184, s[20:23], s65 offen nt lds
  s_add_u32 m0, s67, 896
  s_add_u32 s67, s67, 8192
  buffer_load_dwordx4 v184, s[20:23], s65 offen offset:128 nt lds
  s_add_u32 s65, s65, s70
  s_bitset0_b32 s67, 16
  s_mov_b32 m0, s68
  s_nop 0
  buffer_load_dwordx4 v185, s[24:27], s66 offen nt lds
  s_add_u32 m0, s68, 896
  s_add_u32 s68, s68, 8192
  buffer_load_dwordx4 v185, s[24:27], s66 offen offset:128 nt lds
  s_add_u32 s66, s66, s71
  s_bitset1_b32 s68, 16
  s_bitset0_b32 s68, 17
  s_mov_b32 s59, 0xffff
  s_waitcnt vmcnt(20)
  s_barrier
  s_mov_b32 m0, s67
  s_nop 0
  buffer_load_dwordx4 v184, s[20:23], s65 offen nt lds
  s_add_u32 m0, s67, 896
  s_add_u32 s67, s67, 8192
  buffer_load_dwordx4 v184, s[20:23], s65 offen offset:128 nt lds
  s_add_u32 s65, s65, s70
  s_bitset0_b32 s67, 16
  s_mov_b32 m0, s68
  s_nop 0
  buffer_load_dwordx4 v185, s[24:27], s66 offen nt lds
  s_add_u32 m0, s68, 896
  s_add_u32 s68, s68, 8192
  buffer_load_dwordx4 v185, s[24:27], s66 offen offset:128 nt lds
  s_add_u32 s66, s66, s71
  s_bitset1_b32 s68, 16
  s_bitset0_b32 s68, 17
  s_waitcnt vmcnt(20)
  s_barrier
  ds_read_b128 v[176:179], v189 offset:0
  ds_read_b128 v[168:171], v189 offset:1024
  ds_read_b64_tr_b16 v[104:105], v187 offset:0
  ds_read_b64_tr_b16 v[106:107], v187 offset:4096
  ds_read_b64_tr_b16 v[108:109], v188 offset:0
  ds_read_b64_tr_b16 v[110:111], v188 offset:4096
  ds_read_b64_tr_b16 v[112:113], v187 offset:512
  ds_read_b64_tr_b16 v[114:115], v187 offset:4608
  ds_read_b64_tr_b16 v[116:117], v188 offset:512
  ds_read_b64_tr_b16 v[118:119], v188 offset:4608
  ds_read_b64_tr_b16 v[120:121], v187 offset:1024
  ds_read_b64_tr_b16 v[122:123], v187 offset:5120
  ds_read_b64_tr_b16 v[124:125], v188 offset:1024
  ds_read_b64_tr_b16 v[126:127], v188 offset:5120
  ds_read_b64_tr_b16 v[128:129], v187 offset:1536
  ds_read_b64_tr_b16 v[130:131], v187 offset:5632
  ds_read_b64_tr_b16 v[132:133], v188 offset:1536
  ds_read_b64_tr_b16 v[134:135], v188 offset:5632
  s_mov_b32 m0, s67
  s_nop 0
  buffer_load_dwordx4 v184, s[20:23], s65 offen nt lds
  s_add_u32 m0, s67, 896
  s_add_u32 s67, s67, 8192
  buffer_load_dwordx4 v184, s[20:23], s65 offen offset:128 nt lds
  s_add_u32 s65, s65, s70
  s_bitset0_b32 s67, 16
  s_mov_b32 m0, s68
  s_nop 0
  buffer_load_dwordx4 v185, s[24:27], s66 offen nt lds
  s_add_u32 m0, s68, 896
  s_add_u32 s68, s68, 8192
  buffer_load_dwordx4 v185, s[24:27], s66 offen offset:128 nt lds
  s_add_u32 s66, s66, s71
  s_bitset1_b32 s68, 16
  s_bitset0_b32 s68, 17
  s_waitcnt lgkmcnt(0)
  v_cmp_gt_i32 vcc, 0, v176
  s_cbranch_vccnz L_BST_p0
L_BRET_p0:
  v_mfma_f32_16x16x32_bf16 v[192:195], v[204:207], v[176:179], v[192:195]
  ds_read_b64_tr_b16 v[136:137], v187 offset:8192
  v_mfma_f32_16x16x32_bf16 v[8:11], v[104:107], v[176:179], v[8:11]
  ds_read_b64_tr_b16 v[138:139], v187 offset:12288
  v_mfma_f32_16x16x32_bf16 v[12:15], v[108:111], v[176:179], v[12:15]
  ds_read_b64_tr_b16 v[140:141], v188 offset:8192
  v_mfma_f32_16x16x32_bf16 v[16:19], v[112:115], v[176:179], v[16:19]
  ds_read_b64_tr_b16 v[142:143], v188 offset:12288
  v_mfma_f32_16x16x32_bf16 v[20:23], v[116:119], v[176:179], v[20:23]
  ds_read_b64_tr_b16 v[144:145], v187 offset:8704
  v_mfma_f32_16x16x32_bf16 v[24:27], v[120:123], v[176:179], v[24:27]
  ds_read_b64_tr_b16 v[146:147], v187 offset:12800
  v_mfma_f32_16x16x32_bf16 v[28:31], v[124:127], v[176:179], v[28:31]
  v_mfma_f32_16x16x32_bf16 v[32:35], v[128:131], v[176:179], v[32:35]
  v_mfma_f32_16x16x32_bf16 v[36:39], v[132:135], v[176:179], v[36:39]
  v_cmp_gt_i32 vcc, 0, v168
  s_cbranch_vccnz L_BST_p1
L_BRET_p1:
  s_mov_b32 s64, 2
  .p2align 6
L_B_LOOPS:
  s_waitcnt vmcnt(20)
  s_barrier
  v_mfma_f32_16x16x32_bf16 v[196:199], v[204:207], v[168:171], v[196:199]
  ds_read_b128 v[172:175], v189 offset:2048
  ds_read_b128 v[176:179], v189 offset:3072
  v_mfma_f32_16x16x32_bf16 v[40:43], v[104:107], v[168:171], v[40:43]
  ds_read_b128 v[180:183], v189 offset:4096
  ds_read_b64_tr_b16 v[148:149], v188 offset:8704
  v_mfma_f32_16x16x32_bf16 v[44:47], v[108:111], v[168:171], v[44:47]
  s_mov_b32 m0, s67
  v_mfma_f32_16x16x32_bf16 v[48:51], v[112:115], v[168:171], v[48:51]
  buffer_load_dwordx4 v184, s[20:23], s65 offen nt lds
  v_mfma_f32_16x16x32_bf16 v[52:55], v[116:119], v[168:171], v[52:55]
  s_add_u32 m0, s67, 896
  s_add_u32 s67, s67, 8192
  v_mfma_f32_16x16x32_bf16 v[56:59], v[120:123], v[168:171], v[56:59]
  ds_read_b64_tr_b16 v[150:151], v188 offset:12800
  ds_read_b64_tr_b16 v[152:153], v187 offset:9216
  v_mfma_f32_16x16x32_bf16 v[60:63], v[124:127], v[168:171], v[60:63]
  ds_read_b64_tr_b16 v[154:155], v187 offset:13312
  ds_read_b64_tr_b16 v[156:157], v188 offset:9216
  v_mfma_f32_16x16x32_bf16 v[64:67], v[128:131], v[168:171], v[64:67]
  v_mfma_f32_16x16x32_bf16 v[68:71], v[132:135], v[168:171], v[68:71]
  s_waitcnt lgkmcnt(5)
  v_cmp_gt_i32 vcc, 0, v172
  s_cbranch_vccnz L_BST_aeS
L_BRET_aeS:
  v_mfma_f32_16x16x32_bf16 v[200:203], v[204:207], v[172:175], v[200:203]
  ds_read_b64_tr_b16 v[158:159], v188 offset:13312
  ds_read_b64_tr_b16 v[160:161], v187 offset:9728
  v_mfma_f32_16x16x32_bf16 v[72:75], v[104:107], v[172:175], v[72:75]
  v_mfma_f32_16x16x32_bf16 v[76:79], v[108:111], v[172:175], v[76:79]
  buffer_load_dwordx4 v184, s[20:23], s65 offen offset:128 nt lds
  v_mfma_f32_16x16x32_bf16 v[80:83], v[112:115], v[172:175], v[80:83]
  s_add_u32 s65, s65, s70
  s_bitset0_b32 s67, 16
  s_mov_b32 m0, s68
  v_mfma_f32_16x16x32_bf16 v[84:87], v[116:119], v[172:175], v[84:87]
  ds_read_b64_tr_b16 v[162:163], v187 offset:13824
  ds_read_b64_tr_b16 v[164:165], v188 offset:9728
  v_mfma_f32_16x16x32_bf16 v[88:91], v[120:123], v[172:175], v[88:91]
  ds_read_b64_tr_b16 v[166:167], v188 offset:13824
  v_mfma_f32_16x16x32_bf16 v[92:95], v[124:127], v[172:175], v[92:95]
  v_mfma_f32_16x16x32_bf16 v[96:99], v[128:131], v[172:175], v[96:99]
  v_add_u32 v187, 0x4000, v187
  v_and_or_b32 v187, v187, s59, v211
  v_xor_b32 v188, 32, v187
  v_mfma_f32_16x16x32_bf16 v[100:103], v[132:135], v[172:175], v[100:103]
  buffer_load_dwordx4 v185, s[24:27], s66 offen nt lds
  s_waitcnt lgkmcnt(0)
  v_cmp_gt_i32 vcc, 0, v176
  s_cbranch_vccnz L_BST_beS
L_BRET_beS:
  v_mfma_f32_16x16x32_bf16 v[192:195], v[204:207], v[176:179], v[192:195]
  s_add_u32 m0, s68, 896
  s_add_u32 s68, s68, 8192
  v_mfma_f32_16x16x32_bf16 v[8:11], v[136:139], v[176:179], v[8:11]
  buffer_load_dwordx4 v185, s[24:27], s66 offen offset:128 nt lds
  v_mfma_f32_16x16x32_bf16 v[12:15], v[140:143], v[176:179], v[12:15]
  s_add_u32 s66, s66, s71
  s_bitset1_b32 s68, 16
  s_bitset0_b32 s68, 17
  v_mfma_f32_16x16x32_bf16 v[16:19], v[144:147], v[176:179], v[16:19]
  ds_read_b64_tr_b16 v[104:105], v187 offset:0
  ds_read_b64_tr_b16 v[106:107], v187 offset:4096
  v_mfma_f32_16x16x32_bf16 v[20:23], v[148:151], v[176:179], v[20:23]
  ds_read_b64_tr_b16 v[108:109], v188 offset:0
  ds_read_b64_tr_b16 v[110:111], v188 offset:4096
  v_mfma_f32_16x16x32_bf16 v[24:27], v[152:155], v[176:179], v[24:27]
  ds_read_b64_tr_b16 v[112:113], v187 offset:512
  ds_read_b64_tr_b16 v[114:115], v187 offset:4608
  v_mfma_f32_16x16x32_bf16 v[28:31], v[156:159], v[176:179], v[28:31]
  v_mfma_f32_16x16x32_bf16 v[32:35], v[160:163], v[176:179], v[32:35]
  s_add_u32 s64, s64, 1
  v_mfma_f32_16x16x32_bf16 v[36:39], v[164:167], v[176:179], v[36:39]
  v_cmp_gt_i32 vcc, 0, v180
  s_cbranch_vccnz L_BST_ceS
L_BRET_ceS:
  s_waitcnt vmcnt(20)
  s_barrier
  v_mfma_f32_16x16x32_bf16 v[196:199], v[204:207], v[180:183], v[196:199]
  ds_read_b128 v[172:175], v189 offset:5120
  ds_read_b128 v[176:179], v189 offset:0
  v_mfma_f32_16x16x32_bf16 v[40:43], v[136:139], v[180:183], v[40:43]
  ds_read_b128 v[168:171], v189 offset:1024
  ds_read_b64_tr_b16 v[116:117], v188 offset:512
  v_mfma_f32_16x16x32_bf16 v[44:47], v[140:143], v[180:183], v[44:47]
  s_mov_b32 m0, s67
  v_mfma_f32_16x16x32_bf16 v[48:51], v[144:147], v[180:183], v[48:51]
  buffer_load_dwordx4 v184, s[20:23], s65 offen nt lds
  v_mfma_f32_16x16x32_bf16 v[52:55], v[148:151], v[180:183], v[52:55]
  s_add_u32 m0, s67, 896
  s_add_u32 s67, s67, 8192
  v_mfma_f32_16x16x32_bf16 v[56:59], v[152:155], v[180:183], v[56:59]
  ds_read_b64_tr_b16 v[118:119], v188 offset:4608
  ds_read_b64_tr_b16 v[120:121], v187 offset:1024
  v_mfma_f32_16x16x32_bf16 v[60:63], v[156:159], v[180:183], v[60:63]
  ds_read_b64_tr_b16 v[122:123], v187 offset:5120
  ds_read_b64_tr_b16 v[124:125], v188 offset:1024
  v_mfma_f32_16x16x32_bf16 v[64:67], v[160:163], v[180:183], v[64:67]
  v_mfma_f32_16x16x32_bf16 v[68:71], v[164:167], v[180:183], v[68:71]
  s_waitcnt lgkmcnt(5)
  v_cmp_gt_i32 vcc, 0, v172
  s_cbranch_vccnz L_BST_aoS
L_BRET_aoS:
  v_mfma_f32_16x16x32_bf16 v[200:203], v[204:207], v[172:175], v[200:203]
  ds_read_b64_tr_b16 v[126:127], v188 offset:5120
  ds_read_b64_tr_b16 v[128:129], v187 offset:1536
  v_mfma_f32_16x16x32_bf16 v[72:75], v[136:139], v[172:175], v[72:75]
  v_mfma_f32_16x16x32_bf16 v[76:79], v[140:143], v[172:175], v[76:79]
  buffer_load_dwordx4 v184, s[20:23], s65 offen offset:128 nt lds
  v_mfma_f32_16x16x32_bf16 v[80:83], v[144:147], v[172:175], v[80:83]
  s_add_u32 s65, s65, s70
  s_bitset0_b32 s67, 16
  s_mov_b32 m0, s68
  v_mfma_f32_16x16x32_bf16 v[84:87], v[148:151], v[172:175], v[84:87]
  ds_read_b64_tr_b16 v[130:131], v187 offset:5632
  ds_read_b64_tr_b16 v[132:133], v188 offset:1536
  v_mfma_f32_16x16x32_bf16 v[88:91], v[152:155], v[172:175], v[88:91]
  ds_read_b64_tr_b16 v[134:135], v188 offset:5632
  v_mfma_f32_16x16x32_bf16 v[92:95], v[156:159], v[172:175], v[92:95]
  v_mfma_f32_16x16x32_bf16 v[96:99], v[160:163], v[172:175], v[96:99]
  s_cmp_eq_u32 s64, 17
  v_mfma_f32_16x16x32_bf16 v[100:103], v[164:167], v[172:175], v[100:103]
  buffer_load_dwordx4 v185, s[24:27], s66 offen nt lds
  s_cbranch_scc1 L_B_DONES
  s_waitcnt lgkmcnt(0)
  v_cmp_gt_i32 vcc, 0, v176
  s_cbranch_vccnz L_BST_boS
L_BRET_boS:
  v_mfma_f32_16x16x32_bf16 v[192:195], v[204:207], v[176:179], v[192:195]
  s_add_u32 m0, s68, 896
  s_add_u32 s68, s68, 8192
  v_mfma_f32_16x16x32_bf16 v[8:11], v[104:107], v[176:179], v[8:11]
  buffer_load_dwordx4 v185, s[24:27], s66 offen offset:128 nt lds
  v_mfma_f32_16x16x32_bf16 v[12:15], v[108:111], v[176:179], v[12:15]
  s_add_u32 s66, s66, s71
  s_bitset1_b32 s68, 16
  s_bitset0_b32 s68, 17
  v_mfma_f32_16x16x32_bf16 v[16:19], v[112:115], v[176:179], v[16:19]
  ds_read_b64_tr_b16 v[136:137], v187 offset:8192
  ds_read_b64_tr_b16 v[138:139], v187 offset:12288
  v_mfma_f32_16x16x32_bf16 v[20:23], v[116:119], v[176:179], v[20:23]
  ds_read_b64_tr_b16 v[140:141], v188 offset:8192
  ds_read_b64_tr_b16 v[142:143], v188 offset:12288
  v_mfma_f32_16x16x32_bf16 v[24:27], v[120:123], v[176:179], v[24:27]
  ds_read_b64_tr_b16 v[144:145], v187 offset:8704
  ds_read_b64_tr_b16 v[146:147], v187 offset:12800
  v_mfma_f32_16x16x32_bf16 v[28:31], v[124:127], v[176:179], v[28:31]
  v_mfma_f32_16x16x32_bf16 v[32:35], v[128:131], v[176:179], v[32:35]
  s_add_u32 s64, s64, 1
  v_mfma_f32_16x16x32_bf16 v[36:39], v[132:135], v[176:179], v[36:39]
  v_cmp_gt_i32 vcc, 0, v168
  s_cbranch_vccnz L_BST_coS
L_BRET_coS:
  s_cmp_eq_u32 s64, s72
  s_cbranch_scc0 L_B_LOOPS
L_BEVS:
  s_cmp_eq_u32 s64, 8
  s_cbranch_scc0 L_BEV2S
  s_mov_b32 s20, s12
  s_and_b32 s21, s13, 0xffff
  s_mov_b32 s22, 0x400000
  s_lshl_b32 s65, s49, 19
  s_lshl_b32 s54, s53, 13
  s_add_u32 s65, s65, s54
  s_lshl_b32 s54, s50, 8
  s_add_u32 s65, s65, s54
  s_mov_b32 s70, 0x8000
  v_mov_b32 v184, v186
  s_mov_b32 s72, 10
  s_branch L_B_LOOPS
L_BEV2S:
  s_cmp_eq_u32 s64, 10
  s_cbranch_scc0 L_BEV3S
  s_mov_b32 s24, s12
  s_and_b32 s25, s13, 0xffff
  s_mov_b32 s26, 0x400000
  s_lshl_b32 s66, s49, 19
  s_lshl_b32 s54, s53, 13
  s_add_u32 s66, s66, s54
  s_lshl_b32 s54, s50, 8
  s_add_u32 s66, s66, s54
  s_add_u32 s66, s66, 0x40000
  s_mov_b32 s71, 0x8000
  v_mov_b32 v185, v186
  s_mov_b32 s72, 16
  s_branch L_B_LOOPS
L_BEV3S:
  s_mov_b32 s22, 0
  s_mov_b32 s67, 0x28000
  s_branch L_B_LOOPS
L_B_DONES:
  s_add_u32 m0, s68, 896
  s_add_u32 s68, s68, 8192
  buffer_load_dwordx4 v185, s[24:27], s66 offen offset:128 nt lds
  s_branch L_B_DONE
L_BST_p0:
  ds_read_b32 v191, v190 offset:0
  v_and_b32 v176, 0x7fffffff, v176
  s_call_b64 s[60:61], L_BRESC0
  s_branch L_BRET_p0
L_BST_p1:
  ds_read_b32 v191, v190 offset:256
  v_and_b32 v168, 0x7fffffff, v168
  s_call_b64 s[60:61], L_BRESC1
  s_branch L_BRET_p1
L_BST_aeS:
  ds_read_b32 v191, v190 offset:512
  v_and_b32 v172, 0x7fffffff, v172
  s_call_b64 s[60:61], L_BRESC2
  s_branch L_BRET_aeS
L_BST_beS:
  ds_read_b32 v191, v190 offset:768
  v_and_b32 v176, 0x7fffffff, v176
  s_call_b64 s[60:61], L_BRESC0
  s_branch L_BRET_beS
L_BST_ceS:
  ds_read_b32 v191, v190 offset:1024
  v_and_b32 v180, 0x7fffffff, v180
  s_call_b64 s[60:61], L_BRESC1
  s_branch L_BRET_ceS
L_BST_aoS:
  ds_read_b32 v191, v190 offset:1280
  v_and_b32 v172, 0x7fffffff, v172
  s_call_b64 s[60:61], L_BRESC2
  s_branch L_BRET_aoS
L_BST_boS:
  ds_read_b32 v191, v190 offset:0
  v_and_b32 v176, 0x7fffffff, v176
  s_call_b64 s[60:61], L_BRESC0
  s_branch L_BRET_boS
L_BST_coS:
  ds_read_b32 v191, v190 offset:256
  v_and_b32 v168, 0x7fffffff, v168
  s_call_b64 s[60:61], L_BRESC1
  s_branch L_BRET_coS
L_BRESC0:
  s_nop 7
  s_waitcnt lgkmcnt(0)
  v_mul_f32 v8, v8, v191
  v_mul_f32 v9, v9, v191
  v_mul_f32 v10, v10, v191
  v_mul_f32 v11, v11, v191
  v_mul_f32 v12, v12, v191
  v_mul_f32 v13, v13, v191
  v_mul_f32 v14, v14, v191
  v_mul_f32 v15, v15, v191
  v_mul_f32 v16, v16, v191
  v_mul_f32 v17, v17, v191
  v_mul_f32 v18, v18, v191
  v_mul_f32 v19, v19, v191
  v_mul_f32 v20, v20, v191
  v_mul_f32 v21, v21, v191
  v_mul_f32 v22, v22, v191
  v_mul_f32 v23, v23, v191
  v_mul_f32 v24, v24, v191
  v_mul_f32 v25, v25, v191
  v_mul_f32 v26, v26, v191
  v_mul_f32 v27, v27, v191
  v_mul_f32 v28, v28, v191
  v_mul_f32 v29, v29, v191
  v_mul_f32 v30, v30, v191
  v_mul_f32 v31, v31, v191
  v_mul_f32 v32, v32, v191
  v_mul_f32 v33, v33, v191
  v_mul_f32 v34, v34, v191
  v_mul_f32 v35, v35, v191
  v_mul_f32 v36, v36, v191
  v_mul_f32 v37, v37, v191
  v_mul_f32 v38, v38, v191
  v_mul_f32 v39, v39, v191
  v_mul_f32 v192, v192, v191
  v_mul_f32 v193, v193, v191
  v_mul_f32 v194, v194, v191
  v_mul_f32 v195, v195, v191
  s_nop 1
  s_setpc_b64 s[60:61]
L_BRESC1:
  s_nop 7
  s_waitcnt lgkmcnt(0)
  v_mul_f32 v40, v40, v191
  v_mul_f32 v41, v41, v191
  v_mul_f32 v42, v42, v191
  v_mul_f32 v43, v43, v191
  v_mul_f32 v44, v44, v191
  v_mul_f32 v45, v45, v191
  v_mul_f32 v46, v46, v191
  v_mul_f32 v47, v47, v191
  v_mul_f32 v48, v48, v191
  v_mul_f32 v49, v49, v191
  v_mul_f32 v50, v50, v191
  v_mul_f32 v51, v51, v191
  v_mul_f32 v52, v52, v191
  v_mul_f32 v53, v53, v191
  v_mul_f32 v54, v54, v191
  v_mul_f32 v55, v55, v191
  v_mul_f32 v56, v56, v191
  v_mul_f32 v57, v57, v191
  v_mul_f32 v58, v58, v191
  v_mul_f32 v59, v59, v191
  v_mul_f32 v60, v60, v191
  v_mul_f32 v61, v61, v191
  v_mul_f32 v62, v62, v191
  v_mul_f32 v63, v63, v191
  v_mul_f32 v64, v64, v191
  v_mul_f32 v65, v65, v191
  v_mul_f32 v66, v66, v191
  v_mul_f32 v67, v67, v191
  v_mul_f32 v68, v68, v191
  v_mul_f32 v69, v69, v191
  v_mul_f32 v70, v70, v191
  v_mul_f32 v71, v71, v191
  v_mul_f32 v196, v196, v191
  v_mul_f32 v197, v197, v191
  v_mul_f32 v198, v198, v191
  v_mul_f32 v199, v199, v191
  s_nop 1
  s_setpc_b64 s[60:61]
L_BRESC2:
  s_nop 7
  s_waitcnt lgkmcnt(0)
  v_mul_f32 v72, v72, v191
  v_mul_f32 v73, v73, v191
  v_mul_f32 v74, v74, v191
  v_mul_f32 v75, v75, v191
  v_mul_f32 v76, v76, v191
  v_mul_f32 v77, v77, v191
  v_mul_f32 v78, v78, v191
  v_mul_f32 v79, v79, v191
  v_mul_f32 v80, v80, v191
  v_mul_f32 v81, v81, v191
  v_mul_f32 v82, v82, v191
  v_mul_f32 v83, v83, v191
  v_mul_f32 v84, v84, v191
  v_mul_f32 v85, v85, v191
  v_mul_f32 v86, v86, v191
  v_mul_f32 v87, v87, v191
  v_mul_f32 v88, v88, v191
  v_mul_f32 v89, v89, v191
  v_mul_f32 v90, v90, v191
  v_mul_f32 v91, v91, v191
  v_mul_f32 v92, v92, v191
  v_mul_f32 v93, v93, v191
  v_mul_f32 v94, v94, v191
  v_mul_f32 v95, v95, v191
  v_mul_f32 v96, v96, v191
  v_mul_f32 v97, v97, v191
  v_mul_f32 v98, v98, v191
  v_mul_f32 v99, v99, v191
  v_mul_f32 v100, v100, v191
  v_mul_f32 v101, v101, v191
  v_mul_f32 v102, v102, v191
  v_mul_f32 v103, v103, v191
  v_mul_f32 v200, v200, v191
  v_mul_f32 v201, v201, v191
  v_mul_f32 v202, v202, v191
  v_mul_f32 v203, v203, v191
  s_nop 1
  s_setpc_b64 s[60:61]
  s_endpgm
L_CODE_END:

.section .rodata,"a"
.p2align 6
.amdhsa_kernel standalone__gqa_block_cached__near_ridge_kernel
  .amdhsa_next_free_vgpr 256
  .amdhsa_next_free_sgpr 102
  .amdhsa_accum_offset 256
  .amdhsa_group_segment_fixed_size 0
  .amdhsa_kernarg_size 64
  .amdhsa_user_sgpr_count 2
  .amdhsa_user_sgpr_kernarg_segment_ptr 1
  .amdhsa_system_sgpr_workgroup_id_x 1
.end_amdhsa_kernel
```
